```python
import torch

def _softmax(x, axis=-1):
    return torch.softmax(x, dim=axis)
def _gelu(x):
    return torch.nn.functional.gelu(x, approximate="tanh")
def _silu(x):
    return torch.nn.functional.silu(x)
def _sigmoid(x):
    return torch.sigmoid(x)
def _layernorm(x, axis=-1, eps=1e-5):
    m = x.mean(dim=axis, keepdim=True)
    v = x.var(dim=axis, keepdim=True, unbiased=False)
    return (x - m) / torch.sqrt(v + eps)
def _scatter_add(tgt, idx, src, axis=0):
    return tgt.clone().index_add_(axis, idx, src)
def _segment_sum(src, seg, n):
    out = torch.zeros((n,) + src.shape[1:], dtype=src.dtype)
    return out.index_add_(0, seg, src)
def _pad(x, pw):
    flat = tuple(v for pair in reversed(pw) for v in pair)
    return torch.nn.functional.pad(x, flat)

kernel_name = 'gated_mix__grouped_kv_mqa__glu_gated_bilinear__prompt'

def setup_inputs():

    _w = (lambda a: (lambda t: t.to(torch.bfloat16) if t.is_floating_point() else t)(torch.as_tensor(a)))
    def _A_setup():
        B, S, D, H = 1, 2048, 512, 32
        Dh = D // H
        return {
            "x": _w((lambda *s: torch.randn(*s, dtype=torch.bfloat16) * 0.05)(B, S, D)),
            "wq": _w((lambda *s: torch.randn(*s, dtype=torch.bfloat16) * 0.8)(D, H * Dh)),
            "wk": _w((lambda *s: torch.randn(*s, dtype=torch.bfloat16) * 0.8)(D, Dh)),
            "wv": _w((lambda *s: torch.randn(*s, dtype=torch.bfloat16) * 0.05)(D, Dh)),
            "wo": _w((lambda *s: torch.randn(*s, dtype=torch.bfloat16) * 0.05)(H * Dh, D)),
        }
    _A_in = _A_setup()

    def _B_setup():
        B, S, D, F = 1, 2048, 512, 1792
        return {
            "x": _w((lambda *s: torch.randn(*s, dtype=torch.bfloat16) * 0.05)(B, S, D)),
            "w_gate": _w((lambda *s: torch.randn(*s, dtype=torch.bfloat16) * 0.8)(D, F) * (D ** -0.5)),
            "w_up": _w((lambda *s: torch.randn(*s, dtype=torch.bfloat16) * 0.8)(D, F) * (D ** -0.5)),
            "w_down": _w((lambda *s: torch.randn(*s, dtype=torch.bfloat16) * 0.8)(F, D) * (F ** -0.5)),
        }
    _B_in = _B_setup()

    return {
        "A_x": _A_in["x"],
        "A_wq": _A_in["wq"],
        "A_wk": _A_in["wk"],
        "A_wv": _A_in["wv"],
        "A_wo": _A_in["wo"],
        "B_x": _B_in["x"],
        "B_w_gate": _B_in["w_gate"],
        "B_w_up": _B_in["w_up"],
        "B_w_down": _B_in["w_down"],
        "gate_w": _w((lambda *s: torch.randn(*s, dtype=torch.bfloat16) * 0.05)(512) * 16.0),
    }

def reference(A_x, A_wq, A_wk, A_wv, A_wo, B_x, B_w_gate, B_w_up, B_w_down, gate_w):
    def _A_ref(x, wq, wk, wv, wo):
        B, S, D = x.shape
        H = 32
        Dh = D // H
        q = (lambda x, *d: x.permute(*d))((x @ wq).reshape(B, S, H, Dh), 0, 2, 1, 3)
        k = x @ wk
        v = x @ wv
        scores = torch.einsum("bhqd,bkd->bhqk", q, k) * (Dh ** -0.5)
        p = _softmax(scores, axis=-1)
        o = torch.einsum("bhqk,bkd->bhqd", p, v)
        return (lambda x, *d: x.permute(*d))(o, 0, 2, 1, 3).reshape(B, S, H * Dh) @ wo

    def _B_ref(x, w_gate, w_up, w_down):
        g = torch.einsum("bsd,df->bsf", x, w_gate)
        u = torch.einsum("bsd,df->bsf", x, w_up)
        h = g * u
        return torch.einsum("bsf,fd->bsd", h, w_down)

    x = A_x
    g = _sigmoid((x * gate_w).sum(-1, keepdims=True))
    a = _A_ref(x, A_wq, A_wk, A_wv, A_wo)
    b = _B_ref(x, B_w_gate, B_w_up, B_w_down)
    return g * a + (1 - g) * b
```

```asm
; @launch grid=(256,1,1) block=(768,1,1) lds=163840
.amdgcn_target "amdgcn-amd-amdhsa--gfx950"
.text
.globl gated_mix__grouped_kv_mqa__glu_gated_bilinear__prompt_kernel
.p2align 8
.type gated_mix__grouped_kv_mqa__glu_gated_bilinear__prompt_kernel,@function
gated_mix__grouped_kv_mqa__glu_gated_bilinear__prompt_kernel:
    s_cmp_ge_u32 s2, 256
    s_cbranch_scc1 L_END
    s_load_dwordx16 s[16:31], s[0:1], 0
    s_load_dwordx8 s[32:39], s[0:1], 64
    s_load_dwordx2 s[40:41], s[0:1], 96
    s_memrealtime s[88:89]
    v_lshrrev_b32 v1, 6, v0
    v_and_b32 v0, 63, v0
    v_readfirstlane_b32 s3, v1
    s_and_b32 s6, s2, 7
    s_lshr_b32 s7, s2, 3
    s_and_b32 s4, s6, 1
    s_lshl_b32 s4, s4, 3
    s_and_b32 s8, s7, 7
    s_add_u32 s4, s4, s8
    s_lshr_b32 s5, s6, 1
    s_lshl_b32 s5, s5, 2
    s_lshr_b32 s8, s7, 3
    s_add_u32 s5, s5, s8
    s_lshl_b32 s14, s6, 2
    s_and_b32 s8, s7, 3
    s_add_u32 s14, s14, s8
    s_lshr_b32 s15, s7, 2
    v_lshlrev_b32 v1, 4, v0
    s_cmp_ge_u32 s3, 8
    s_cbranch_scc1 L_HELPER
    s_cmp_ge_u32 s3, 4
    s_cbranch_scc1 L_NOTOUCH
    s_waitcnt lgkmcnt(0)
    s_mov_b32 s60, s16
    s_mov_b32 s61, s17
    s_cmp_eq_u32 s3, 1
    s_cselect_b32 s60, s28, s60
    s_cselect_b32 s61, s29, s61
    s_cmp_eq_u32 s3, 2
    s_cselect_b32 s60, s30, s60
    s_cselect_b32 s61, s31, s61
    s_cmp_eq_u32 s3, 3
    s_cselect_b32 s60, s18, s60
    s_cselect_b32 s61, s19, s61
    s_mov_b32 s62, 1024
    s_mov_b32 s63, 0x20000
    v_mov_b32 v2, 0
    s_mov_b64 exec, 1
    buffer_load_dword v160, v2, s[60:63], 0 offen
    s_mov_b64 exec, -1
L_NOTOUCH:
    s_waitcnt lgkmcnt(0)
    s_mov_b32 s63, 0x20000
    s_lshl_b32 s6, s4, 4
    s_add_u32 s6, s6, s5
    s_lshl_b32 s6, s6, 3
    s_add_u32 s6, s6, s3
    s_lshl_b32 s6, s6, 10
    s_mov_b32 s60, s16
    s_mov_b32 s61, s17
    s_mov_b32 s62, 0x200000
    buffer_load_dwordx4 v[128:131], v1, s[60:63], s6 offen
    s_cmp_eq_u32 s3, 7
    s_cbranch_scc1 L_PF7
    s_mul_i32 s6, s2, 7
    s_add_u32 s6, s6, s3
    s_lshl_b32 s6, s6, 10
    s_mov_b32 s62, 0x1c0000
    s_mov_b32 s63, 0x20000
    s_mov_b32 s60, s28
    s_mov_b32 s61, s29
    buffer_load_dwordx4 v[160:163], v1, s[60:63], s6 offen
    s_mov_b32 s60, s30
    s_mov_b32 s61, s31
    buffer_load_dwordx4 v[160:163], v1, s[60:63], s6 offen
    s_branch L_PFE
L_PF7:
    s_lshl_b32 s6, s2, 11
    s_mov_b32 s62, 0x80000
    s_getpc_b64 s[90:91]
L_PC:
    s_sub_u32 s90, s90, L_PC-gated_mix__grouped_kv_mqa__glu_gated_bilinear__prompt_kernel
    s_subb_u32 s91, s91, 0
    s_lshr_b32 s7, s2, 3
    s_lshl_b32 s7, s7, 10
    v_add_u32 v2, s7, v1
    v_cmp_gt_u32 vcc, L_CODE_END-gated_mix__grouped_kv_mqa__glu_gated_bilinear__prompt_kernel-16, v2
    s_and_saveexec_b64 s[92:93], vcc
    s_cbranch_execz L_PCX
    global_load_dwordx4 v[160:163], v2, s[90:91]
L_PCX:
    s_mov_b64 exec, -1
    s_mov_b32 s60, s18
    s_mov_b32 s61, s19
    buffer_load_dwordx4 v[160:163], v1, s[60:63], s6 offen
    buffer_load_dwordx4 v[160:163], v1, s[60:63], s6 offen offset:1024
L_PFE:
    s_mov_b32 s60, s34
    s_mov_b32 s61, s35
    s_mov_b32 s62, 1024
    buffer_load_dwordx4 v[132:135], v1, s[60:63], 0 offen
    s_branch L_MAIN
L_HELPER:
    s_setprio 3
    s_sub_u32 s72, s3, 8
    s_lshl_b32 s73, s72, 12
    s_lshl_b32 s74, s72, 13
    s_lshl_b32 s6, s4, 7
    s_lshl_b32 s7, s72, 5
    s_add_u32 s6, s6, s7
    v_lshrrev_b32 v21, 3, v0
    v_add_u32 v21, s6, v21
    v_lshlrev_b32 v21, 10, v21
    v_and_b32 v22, 7, v0
    v_lshrrev_b32 v23, 4, v0
    v_xor_b32 v22, v22, v23
    v_lshl_add_u32 v2, v22, 4, v21
    v_xor_b32 v3, 64, v2
    v_add_u32 v3, 0x2000, v3
    s_waitcnt lgkmcnt(0)
    s_mov_b32 s44, s16
    s_mov_b32 s45, s17
    s_mov_b32 s46, 0x200000
    s_mov_b32 s47, 0x20000
    s_cmp_lt_u32 s72, 2
    s_cselect_b32 s48, s28, s30
    s_cselect_b32 s49, s29, s31
    s_mov_b32 s50, 0x1c0000
    s_mov_b32 s51, 0x20000
    s_cmp_lt_u32 s72, 2
    s_cselect_b32 s52, s28, s30
    s_cselect_b32 s53, s29, s31
    s_mov_b32 s54, 0x1c0000
    s_cmp_eq_u32 s72, 3
    s_cselect_b32 s52, s18, s52
    s_cselect_b32 s53, s19, s53
    s_cselect_b32 s54, 0x80000, s54
    s_mov_b32 s55, 0x20000
    s_cmp_lt_u32 s72, 1
    s_cselect_b32 s68, s28, s30
    s_cselect_b32 s69, s29, s31
    s_mov_b32 s70, 0x1c0000
    s_cmp_eq_u32 s72, 3
    s_cselect_b32 s68, s18, s68
    s_cselect_b32 s69, s19, s69
    s_cselect_b32 s70, 0x80000, s70
    s_mov_b32 s71, 0x20000
    s_add_u32 m0, s73, 49152
    s_movk_i32 s6, 0
    buffer_load_dwordx4 v2, s[44:47], s6 offen lds
    s_add_u32 m0, s73, 50176
    s_movk_i32 s6, 0
    buffer_load_dwordx4 v3, s[44:47], s6 offen lds
    s_add_u32 m0, s73, 51200
    s_movk_i32 s6, 16384
    buffer_load_dwordx4 v2, s[44:47], s6 offen lds
    s_add_u32 m0, s73, 52224
    s_movk_i32 s6, 16384
    buffer_load_dwordx4 v3, s[44:47], s6 offen lds
    s_mul_i32 s8, s5, 224
    s_movk_i32 s9, 4682
    s_lshl_b32 s6, s72, 3
    s_add_u32 s6, s6, 0
    s_sub_u32 s7, s6, 14
    s_cmp_ge_u32 s6, 14
    s_cselect_b32 s6, s7, s6
    s_cselect_b32 s78, 6, 0
    s_lshl_b32 s6, s6, 6
    v_add_u32 v21, s6, v0
    v_mul_u32_u24 v22, s9, v21
    v_lshrrev_b32 v22, 16, v22
    v_mul_u32_u24 v23, 14, v22
    v_sub_u32 v21, v21, v23
    v_add_u32 v21, s78, v21
    v_subrev_u32 v23, 14, v21
    v_min_u32 v21, v21, v23
    v_mul_u32_u24 v22, 0xe00, v22
    v_lshl_add_u32 v21, v21, 4, v22
    v_add_u32 v4, s8, v21
    s_add_u32 m0, s74, 65536
    s_nop 0
    buffer_load_dwordx4 v4, s[48:51], 0 offen lds
    s_lshl_b32 s6, s72, 3
    s_add_u32 s6, s6, 1
    s_sub_u32 s7, s6, 14
    s_cmp_ge_u32 s6, 14
    s_cselect_b32 s6, s7, s6
    s_cselect_b32 s78, 6, 0
    s_lshl_b32 s6, s6, 6
    v_add_u32 v21, s6, v0
    v_mul_u32_u24 v22, s9, v21
    v_lshrrev_b32 v22, 16, v22
    v_mul_u32_u24 v23, 14, v22
    v_sub_u32 v21, v21, v23
    v_add_u32 v21, s78, v21
    v_subrev_u32 v23, 14, v21
    v_min_u32 v21, v21, v23
    v_mul_u32_u24 v22, 0xe00, v22
    v_lshl_add_u32 v21, v21, 4, v22
    v_add_u32 v5, s8, v21
    s_add_u32 m0, s74, 66560
    s_nop 0
    buffer_load_dwordx4 v5, s[48:51], 0 offen lds
    s_lshl_b32 s6, s72, 3
    s_add_u32 s6, s6, 2
    s_sub_u32 s7, s6, 14
    s_cmp_ge_u32 s6, 14
    s_cselect_b32 s6, s7, s6
    s_cselect_b32 s78, 6, 0
    s_lshl_b32 s6, s6, 6
    v_add_u32 v21, s6, v0
    v_mul_u32_u24 v22, s9, v21
    v_lshrrev_b32 v22, 16, v22
    v_mul_u32_u24 v23, 14, v22
    v_sub_u32 v21, v21, v23
    v_add_u32 v21, s78, v21
    v_subrev_u32 v23, 14, v21
    v_min_u32 v21, v21, v23
    v_mul_u32_u24 v22, 0xe00, v22
    v_lshl_add_u32 v21, v21, 4, v22
    v_add_u32 v6, s8, v21
    s_add_u32 m0, s74, 67584
    s_nop 0
    buffer_load_dwordx4 v6, s[48:51], 0 offen lds
    s_lshl_b32 s6, s72, 3
    s_add_u32 s6, s6, 3
    s_sub_u32 s7, s6, 14
    s_cmp_ge_u32 s6, 14
    s_cselect_b32 s6, s7, s6
    s_cselect_b32 s78, 6, 0
    s_lshl_b32 s6, s6, 6
    v_add_u32 v21, s6, v0
    v_mul_u32_u24 v22, s9, v21
    v_lshrrev_b32 v22, 16, v22
    v_mul_u32_u24 v23, 14, v22
    v_sub_u32 v21, v21, v23
    v_add_u32 v21, s78, v21
    v_subrev_u32 v23, 14, v21
    v_min_u32 v21, v21, v23
    v_mul_u32_u24 v22, 0xe00, v22
    v_lshl_add_u32 v21, v21, 4, v22
    v_add_u32 v7, s8, v21
    s_add_u32 m0, s74, 68608
    s_nop 0
    buffer_load_dwordx4 v7, s[48:51], 0 offen lds
    s_cmp_eq_u32 s72, 3
    s_cbranch_scc1 L_WD_Q
    s_lshl_b32 s6, s72, 3
    s_add_u32 s6, s6, 4
    s_sub_u32 s7, s6, 14
    s_cmp_ge_u32 s6, 14
    s_cselect_b32 s6, s7, s6
    s_cselect_b32 s78, 6, 0
    s_lshl_b32 s6, s6, 6
    v_add_u32 v21, s6, v0
    v_mul_u32_u24 v22, s9, v21
    v_lshrrev_b32 v22, 16, v22
    v_mul_u32_u24 v23, 14, v22
    v_sub_u32 v21, v21, v23
    v_add_u32 v21, s78, v21
    v_subrev_u32 v23, 14, v21
    v_min_u32 v21, v21, v23
    v_mul_u32_u24 v22, 0xe00, v22
    v_lshl_add_u32 v21, v21, 4, v22
    v_add_u32 v8, s8, v21
    s_add_u32 m0, s74, 69632
    s_nop 0
    buffer_load_dwordx4 v8, s[52:55], 0 offen lds
    s_lshl_b32 s6, s72, 3
    s_add_u32 s6, s6, 5
    s_sub_u32 s7, s6, 14
    s_cmp_ge_u32 s6, 14
    s_cselect_b32 s6, s7, s6
    s_cselect_b32 s78, 6, 0
    s_lshl_b32 s6, s6, 6
    v_add_u32 v21, s6, v0
    v_mul_u32_u24 v22, s9, v21
    v_lshrrev_b32 v22, 16, v22
    v_mul_u32_u24 v23, 14, v22
    v_sub_u32 v21, v21, v23
    v_add_u32 v21, s78, v21
    v_subrev_u32 v23, 14, v21
    v_min_u32 v21, v21, v23
    v_mul_u32_u24 v22, 0xe00, v22
    v_lshl_add_u32 v21, v21, 4, v22
    v_add_u32 v9, s8, v21
    s_add_u32 m0, s74, 70656
    s_nop 0
    buffer_load_dwordx4 v9, s[52:55], 0 offen lds
    s_lshl_b32 s6, s72, 3
    s_add_u32 s6, s6, 6
    s_sub_u32 s7, s6, 14
    s_cmp_ge_u32 s6, 14
    s_cselect_b32 s6, s7, s6
    s_cselect_b32 s78, 6, 0
    s_lshl_b32 s6, s6, 6
    v_add_u32 v21, s6, v0
    v_mul_u32_u24 v22, s9, v21
    v_lshrrev_b32 v22, 16, v22
    v_mul_u32_u24 v23, 14, v22
    v_sub_u32 v21, v21, v23
    v_add_u32 v21, s78, v21
    v_subrev_u32 v23, 14, v21
    v_min_u32 v21, v21, v23
    v_mul_u32_u24 v22, 0xe00, v22
    v_lshl_add_u32 v21, v21, 4, v22
    v_add_u32 v10, s8, v21
    s_add_u32 m0, s74, 71680
    s_nop 0
    buffer_load_dwordx4 v10, s[68:71], 0 offen lds
    s_lshl_b32 s6, s72, 3
    s_add_u32 s6, s6, 7
    s_sub_u32 s7, s6, 14
    s_cmp_ge_u32 s6, 14
    s_cselect_b32 s6, s7, s6
    s_cselect_b32 s78, 6, 0
    s_lshl_b32 s6, s6, 6
    v_add_u32 v21, s6, v0
    v_mul_u32_u24 v22, s9, v21
    v_lshrrev_b32 v22, 16, v22
    v_mul_u32_u24 v23, 14, v22
    v_sub_u32 v21, v21, v23
    v_add_u32 v21, s78, v21
    v_subrev_u32 v23, 14, v21
    v_min_u32 v21, v21, v23
    v_mul_u32_u24 v22, 0xe00, v22
    v_lshl_add_u32 v21, v21, 4, v22
    v_add_u32 v11, s8, v21
    s_add_u32 m0, s74, 72704
    s_nop 0
    buffer_load_dwordx4 v11, s[68:71], 0 offen lds
    s_mov_b32 s80, 229376
    s_branch L_WD_E
L_WD_Q:
    s_lshl_b32 s8, s5, 6
    v_lshrrev_b32 v21, 2, v0
    v_and_b32 v22, 3, v0
    v_lshlrev_b32 v21, 10, v21
    v_lshl_add_u32 v21, v22, 4, v21
    v_add_u32 v8, s8, v21
    v_add_u32 v9, 16384, v8
    v_add_u32 v10, 32768, v8
    v_add_u32 v11, 49152, v8
    s_add_u32 m0, s74, 69632
    s_nop 0
    buffer_load_dwordx4 v8, s[52:55], 0 offen lds
    s_add_u32 m0, s74, 70656
    s_nop 0
    buffer_load_dwordx4 v9, s[52:55], 0 offen lds
    s_add_u32 m0, s74, 71680
    s_nop 0
    buffer_load_dwordx4 v10, s[68:71], 0 offen lds
    s_add_u32 m0, s74, 72704
    s_nop 0
    buffer_load_dwordx4 v11, s[68:71], 0 offen lds
    s_mov_b32 s80, 65536
L_WD_E:
    s_mov_b32 s64, s38
    s_mov_b32 s65, s39
    s_mov_b32 s66, 0x100
    s_mov_b32 s67, 0x20000
    s_cmp_lg_u32 s2, 0
    s_cbranch_scc1 L_NOTAG
    s_cmp_lg_u32 s72, 3
    s_cbranch_scc1 L_NOTAG
    s_or_b32 s6, s88, 1
    v_mov_b32 v21, s6
    v_mov_b32 v22, 0
    s_mov_b64 exec, 1
    buffer_store_dword v21, v22, s[64:67], 0 offen sc1
    s_mov_b64 exec, -1
L_NOTAG:
    s_and_b32 s12, s5, 3
    s_lshr_b32 s6, s5, 2
    s_add_u32 s11, s6, 1
    s_cmp_ge_u32 s5, 8
    s_cselect_b32 s11, 0, s11
    s_cmp_eq_u32 s11, 1
    s_cselect_b32 s60, s20, s22
    s_cselect_b32 s61, s21, s23
    s_mov_b32 s62, 16384
    s_mov_b32 s63, 0x20000
    v_lshrrev_b32 v21, 4, v0
    v_and_b32 v22, 15, v0
    v_xor_b32 v22, v22, v21
    v_lshlrev_b32 v21, 10, v21
    v_lshl_add_u32 v18, v22, 4, v21
    s_lshl_b32 s6, s4, 2
    s_add_u32 s6, s6, s12
    s_lshl_b32 s6, s6, 15
    s_lshl_b32 s7, s72, 8
    s_add_u32 s86, s6, s7
    s_cmp_eq_u32 s11, 0
    s_cbranch_scc1 L_NODK1
    s_add_u32 m0, s74, 16384
    v_xor_b32 v21, 0, v18
    s_add_u32 s6, s86, 0
    buffer_load_dwordx4 v21, s[44:47], s6 offen lds
    s_add_u32 m0, s74, 17408
    v_xor_b32 v21, 64, v18
    s_add_u32 s6, s86, 4096
    buffer_load_dwordx4 v21, s[44:47], s6 offen lds
    s_add_u32 m0, s74, 18432
    v_xor_b32 v21, 128, v18
    s_add_u32 s6, s86, 8192
    buffer_load_dwordx4 v21, s[44:47], s6 offen lds
    s_add_u32 m0, s74, 19456
    v_xor_b32 v21, 192, v18
    s_add_u32 s6, s86, 12288
    buffer_load_dwordx4 v21, s[44:47], s6 offen lds
    s_add_u32 m0, s74, 20480
    v_xor_b32 v21, 0, v18
    s_add_u32 s6, s86, 16384
    buffer_load_dwordx4 v21, s[44:47], s6 offen lds
    s_add_u32 m0, s74, 21504
    v_xor_b32 v21, 64, v18
    s_add_u32 s6, s86, 20480
    buffer_load_dwordx4 v21, s[44:47], s6 offen lds
    s_add_u32 m0, s74, 22528
    v_xor_b32 v21, 128, v18
    s_add_u32 s6, s86, 24576
    buffer_load_dwordx4 v21, s[44:47], s6 offen lds
    s_add_u32 m0, s74, 23552
    v_xor_b32 v21, 192, v18
    s_add_u32 s6, s86, 28672
    buffer_load_dwordx4 v21, s[44:47], s6 offen lds
    s_add_u32 m0, s73, 0
    s_nop 0
    buffer_load_dwordx4 v1, s[60:63], s73 offen offset:0 lds
    buffer_load_dwordx4 v1, s[60:63], s73 offen offset:1024 lds
    buffer_load_dwordx4 v1, s[60:63], s73 offen offset:2048 lds
    buffer_load_dwordx4 v1, s[60:63], s73 offen offset:3072 lds
L_NODK1:
    s_mov_b32 s78, 229376
    s_mul_i32 s79, s80, 1
    s_add_u32 m0, s74, 114688
    s_movk_i32 s6, 128
    buffer_load_dwordx4 v4, s[48:51], s78 offen lds
    s_add_u32 m0, s73, 98304
    s_nop 0
    buffer_load_dwordx4 v2, s[44:47], s6 offen lds
    s_add_u32 m0, s74, 115712
    s_nop 0
    buffer_load_dwordx4 v5, s[48:51], s78 offen lds
    s_add_u32 m0, s74, 116736
    s_movk_i32 s6, 128
    buffer_load_dwordx4 v6, s[48:51], s78 offen lds
    s_add_u32 m0, s73, 99328
    s_nop 0
    buffer_load_dwordx4 v3, s[44:47], s6 offen lds
    s_add_u32 m0, s74, 117760
    s_nop 0
    buffer_load_dwordx4 v7, s[48:51], s78 offen lds
    s_add_u32 m0, s74, 118784
    s_movk_i32 s6, 16512
    buffer_load_dwordx4 v8, s[52:55], s79 offen lds
    s_add_u32 m0, s73, 100352
    s_nop 0
    buffer_load_dwordx4 v2, s[44:47], s6 offen lds
    s_add_u32 m0, s74, 119808
    s_nop 0
    buffer_load_dwordx4 v9, s[52:55], s79 offen lds
    s_add_u32 m0, s74, 120832
    s_movk_i32 s6, 16512
    buffer_load_dwordx4 v10, s[68:71], s79 offen lds
    s_add_u32 m0, s73, 101376
    s_nop 0
    buffer_load_dwordx4 v3, s[44:47], s6 offen lds
    s_add_u32 m0, s74, 121856
    s_nop 0
    buffer_load_dwordx4 v11, s[68:71], s79 offen lds
    s_mov_b32 s56, s40
    s_mov_b32 s57, s41
    s_mov_b32 s58, 0x10000000
    s_mov_b32 s59, 0x20000
    s_lshl_b32 s27, s72, 10
    s_lshl_b32 s42, s4, 4
    s_add_u32 s42, s42, s5
    s_lshl_b32 s42, s42, 7
    s_cmp_eq_u32 s72, 0
    s_cselect_b32 s83, s11, 0
    s_waitcnt vmcnt(12)
    s_barrier
    v_mov_b32 v21, 0
    buffer_load_dword v12, v21, s[64:67], 0 offen sc1
    s_cmp_eq_u32 s11, 0
    s_cbranch_scc1 L_I0_N
    v_lshrrev_b32 v22, 5, v0
    v_bfe_u32 v23, v0, 2, 2
    v_lshl_add_u32 v24, v22, 3, v23
    v_and_b32 v23, 3, v0
    v_lshlrev_b32 v24, 5, v24
    v_lshl_add_u32 v24, v23, 3, v24
    s_add_u32 s6, s73, 0
    v_add_u32 v19, s6, v24
    v_and_b32 v23, 31, v0
    v_and_b32 v24, 15, v0
    v_xor_b32 v22, v22, v24
    v_lshlrev_b32 v23, 8, v23
    v_lshl_add_u32 v23, v22, 4, v23
    s_add_u32 s6, s74, 16384
    v_add_u32 v20, s6, v23
    v_and_b32 v22, 16, v0
    v_cmp_eq_u32 vcc, 0, v22
    v_xor_b32 v21, 0, v20
    ds_read_b128 v[32:35], v21
    v_xor_b32 v21, 32, v20
    ds_read_b128 v[36:39], v21
    v_xor_b32 v21, 64, v20
    ds_read_b128 v[40:43], v21
    v_xor_b32 v21, 96, v20
    ds_read_b128 v[44:47], v21
    v_xor_b32 v21, 128, v20
    ds_read_b128 v[48:51], v21
    v_xor_b32 v21, 160, v20
    ds_read_b128 v[52:55], v21
    v_xor_b32 v21, 192, v20
    ds_read_b128 v[56:59], v21
    v_xor_b32 v21, 224, v20
    ds_read_b128 v[60:63], v21
    ds_read_b64_tr_b16 v[128:129], v19 offset:0
    ds_read_b64_tr_b16 v[130:131], v19 offset:128
    ds_read_b64_tr_b16 v[132:133], v19 offset:512
    ds_read_b64_tr_b16 v[134:135], v19 offset:640
    ds_read_b64_tr_b16 v[136:137], v19 offset:1024
    ds_read_b64_tr_b16 v[138:139], v19 offset:1152
    s_waitcnt lgkmcnt(8)
    ds_read_b64_tr_b16 v[140:141], v19 offset:1536
    ds_read_b64_tr_b16 v[142:143], v19 offset:1664
    ds_read_b64_tr_b16 v[144:145], v19 offset:2048
    ds_read_b64_tr_b16 v[146:147], v19 offset:2176
    ds_read_b64_tr_b16 v[148:149], v19 offset:2560
    ds_read_b64_tr_b16 v[150:151], v19 offset:2688
    s_waitcnt lgkmcnt(8)
    ds_read_b64_tr_b16 v[152:153], v19 offset:3072
    ds_read_b64_tr_b16 v[154:155], v19 offset:3200
    ds_read_b64_tr_b16 v[156:157], v19 offset:3584
    ds_read_b64_tr_b16 v[158:159], v19 offset:3712
    s_waitcnt lgkmcnt(0)
    s_mov_b32 s78, 458752
    s_mul_i32 s79, s80, 2
    s_add_u32 m0, s74, 16384
    s_movk_i32 s6, 256
    buffer_load_dwordx4 v4, s[48:51], s78 offen lds
    s_add_u32 m0, s73, 0
    s_nop 0
    buffer_load_dwordx4 v2, s[44:47], s6 offen lds
    s_add_u32 m0, s74, 17408
    s_nop 0
    buffer_load_dwordx4 v5, s[48:51], s78 offen lds
    s_add_u32 m0, s74, 18432
    s_movk_i32 s6, 256
    buffer_load_dwordx4 v6, s[48:51], s78 offen lds
    s_add_u32 m0, s73, 1024
    s_nop 0
    buffer_load_dwordx4 v3, s[44:47], s6 offen lds
    s_add_u32 m0, s74, 19456
    s_nop 0
    buffer_load_dwordx4 v7, s[48:51], s78 offen lds
    s_add_u32 m0, s74, 20480
    s_movk_i32 s6, 16640
    buffer_load_dwordx4 v8, s[52:55], s79 offen lds
    s_add_u32 m0, s73, 2048
    s_nop 0
    buffer_load_dwordx4 v2, s[44:47], s6 offen lds
    s_add_u32 m0, s74, 21504
    s_nop 0
    buffer_load_dwordx4 v9, s[52:55], s79 offen lds
    s_add_u32 m0, s74, 22528
    s_movk_i32 s6, 16640
    buffer_load_dwordx4 v10, s[68:71], s79 offen lds
    s_add_u32 m0, s73, 3072
    s_nop 0
    buffer_load_dwordx4 v3, s[44:47], s6 offen lds
    s_add_u32 m0, s74, 23552
    s_nop 0
    buffer_load_dwordx4 v11, s[68:71], s79 offen lds
    s_cmp_eq_u32 s11, 2
    s_cbranch_scc1 L_SJ_V
    v_mfma_f32_32x32x16_bf16 v[96:111], v[128:131], v[32:35], 0
    v_mfma_f32_32x32x16_bf16 v[96:111], v[132:135], v[36:39], v[96:111]
    v_mfma_f32_32x32x16_bf16 v[96:111], v[136:139], v[40:43], v[96:111]
    v_mfma_f32_32x32x16_bf16 v[96:111], v[140:143], v[44:47], v[96:111]
    v_mfma_f32_32x32x16_bf16 v[96:111], v[144:147], v[48:51], v[96:111]
    v_mfma_f32_32x32x16_bf16 v[96:111], v[148:151], v[52:55], v[96:111]
    v_mfma_f32_32x32x16_bf16 v[96:111], v[152:155], v[56:59], v[96:111]
    v_mfma_f32_32x32x16_bf16 v[96:111], v[156:159], v[60:63], v[96:111]
    s_mov_b64 vcc, -1
    s_branch L_SJ_W
L_SJ_V:
    v_mfma_f32_32x32x16_bf16 v[96:111], v[32:35], v[128:131], 0
    v_mfma_f32_32x32x16_bf16 v[96:111], v[36:39], v[132:135], v[96:111]
    v_mfma_f32_32x32x16_bf16 v[96:111], v[40:43], v[136:139], v[96:111]
    v_mfma_f32_32x32x16_bf16 v[96:111], v[44:47], v[140:143], v[96:111]
    v_mfma_f32_32x32x16_bf16 v[96:111], v[48:51], v[144:147], v[96:111]
    v_mfma_f32_32x32x16_bf16 v[96:111], v[52:55], v[148:151], v[96:111]
    v_mfma_f32_32x32x16_bf16 v[96:111], v[56:59], v[152:155], v[96:111]
    v_mfma_f32_32x32x16_bf16 v[96:111], v[60:63], v[156:159], v[96:111]
L_SJ_W:
    s_waitcnt vmcnt(13)
    s_barrier
    s_nop 9
    v_cndmask_b32 v96, v104, v96, vcc
    v_cndmask_b32 v97, v105, v97, vcc
    v_cndmask_b32 v98, v106, v98, vcc
    v_cndmask_b32 v99, v107, v99, vcc
    v_cndmask_b32 v100, v108, v100, vcc
    v_cndmask_b32 v101, v109, v101, vcc
    v_cndmask_b32 v102, v110, v102, vcc
    v_cndmask_b32 v103, v111, v103, vcc
    s_lshr_b32 s6, s73, 1
    s_add_u32 s6, s6, 147456
    v_add_u32 v22, s6, v1
    ds_write_b128 v22, v[96:99]
    ds_write_b128 v22, v[100:103] offset:1024
    s_branch L_I1
L_I0_N:
    s_mov_b32 s78, 458752
    s_mul_i32 s79, s80, 2
    s_add_u32 m0, s74, 16384
    s_movk_i32 s6, 256
    buffer_load_dwordx4 v4, s[48:51], s78 offen lds
    s_add_u32 m0, s73, 0
    s_nop 0
    buffer_load_dwordx4 v2, s[44:47], s6 offen lds
    s_add_u32 m0, s74, 17408
    s_nop 0
    buffer_load_dwordx4 v5, s[48:51], s78 offen lds
    s_add_u32 m0, s74, 18432
    s_movk_i32 s6, 256
    buffer_load_dwordx4 v6, s[48:51], s78 offen lds
    s_add_u32 m0, s73, 1024
    s_nop 0
    buffer_load_dwordx4 v3, s[44:47], s6 offen lds
    s_add_u32 m0, s74, 19456
    s_nop 0
    buffer_load_dwordx4 v7, s[48:51], s78 offen lds
    s_add_u32 m0, s74, 20480
    s_movk_i32 s6, 16640
    buffer_load_dwordx4 v8, s[52:55], s79 offen lds
    s_add_u32 m0, s73, 2048
    s_nop 0
    buffer_load_dwordx4 v2, s[44:47], s6 offen lds
    s_add_u32 m0, s74, 21504
    s_nop 0
    buffer_load_dwordx4 v9, s[52:55], s79 offen lds
    s_add_u32 m0, s74, 22528
    s_movk_i32 s6, 16640
    buffer_load_dwordx4 v10, s[68:71], s79 offen lds
    s_add_u32 m0, s73, 3072
    s_nop 0
    buffer_load_dwordx4 v3, s[44:47], s6 offen lds
    s_add_u32 m0, s74, 23552
    s_nop 0
    buffer_load_dwordx4 v11, s[68:71], s79 offen lds
    s_waitcnt vmcnt(13)
    s_barrier
L_I1:
    s_mov_b32 s78, 688128
    s_mul_i32 s79, s80, 3
    s_add_u32 m0, s74, 65536
    s_movk_i32 s6, 384
    buffer_load_dwordx4 v4, s[48:51], s78 offen lds
    s_add_u32 m0, s73, 49152
    s_nop 0
    buffer_load_dwordx4 v2, s[44:47], s6 offen lds
    s_add_u32 m0, s74, 66560
    s_nop 0
    buffer_load_dwordx4 v5, s[48:51], s78 offen lds
    s_add_u32 m0, s74, 67584
    s_movk_i32 s6, 384
    buffer_load_dwordx4 v6, s[48:51], s78 offen lds
    s_add_u32 m0, s73, 50176
    s_nop 0
    buffer_load_dwordx4 v3, s[44:47], s6 offen lds
    s_add_u32 m0, s74, 68608
    s_nop 0
    buffer_load_dwordx4 v7, s[48:51], s78 offen lds
    s_add_u32 m0, s74, 69632
    s_movk_i32 s6, 16768
    buffer_load_dwordx4 v8, s[52:55], s79 offen lds
    s_add_u32 m0, s73, 51200
    s_nop 0
    buffer_load_dwordx4 v2, s[44:47], s6 offen lds
    s_add_u32 m0, s74, 70656
    s_nop 0
    buffer_load_dwordx4 v9, s[52:55], s79 offen lds
    s_add_u32 m0, s74, 71680
    s_movk_i32 s6, 16768
    buffer_load_dwordx4 v10, s[68:71], s79 offen lds
    s_add_u32 m0, s73, 52224
    s_nop 0
    buffer_load_dwordx4 v3, s[44:47], s6 offen lds
    s_add_u32 m0, s74, 72704
    s_nop 0
    buffer_load_dwordx4 v11, s[68:71], s79 offen lds
    s_waitcnt vmcnt(12) lgkmcnt(0)
    s_barrier
    s_mov_b32 s26, 0
L_GE_L:
    v_readfirstlane_b32 s13, v12
    s_cmp_lg_u32 s13, 0
    s_cbranch_scc1 L_GE_E
    s_add_u32 s26, s26, 1
    s_cmp_ge_u32 s26, 16384
    s_cbranch_scc1 L_GE_E
    s_sleep 1
    v_mov_b32 v21, 0
    buffer_load_dword v12, v21, s[64:67], 0 offen sc1
    s_waitcnt vmcnt(0)
    s_branch L_GE_L
L_GE_E:
    s_cmp_eq_u32 s83, 0
    s_cbranch_scc1 L_I2_N
    v_add_u32 v23, 149504, v1
    ds_read_b128 v[32:35], v23 offset:0
    ds_read_b128 v[36:39], v23 offset:1024
    ds_read_b128 v[40:43], v23 offset:2048
    ds_read_b128 v[44:47], v23 offset:3072
    ds_read_b128 v[48:51], v23 offset:4096
    ds_read_b128 v[52:55], v23 offset:5120
    s_lshl_b32 s6, s4, 2
    s_add_u32 s6, s6, s12
    s_lshl_b32 s7, s6, 11
    s_waitcnt lgkmcnt(0)
    v_add_f32 v96, v96, v32
    v_add_f32 v97, v97, v33
    v_add_f32 v98, v98, v34
    v_add_f32 v99, v99, v35
    v_add_f32 v100, v100, v36
    v_add_f32 v101, v101, v37
    v_add_f32 v102, v102, v38
    v_add_f32 v103, v103, v39
    v_add_f32 v96, v96, v40
    v_add_f32 v97, v97, v41
    v_add_f32 v98, v98, v42
    v_add_f32 v99, v99, v43
    v_add_f32 v100, v100, v44
    v_add_f32 v101, v101, v45
    v_add_f32 v102, v102, v46
    v_add_f32 v103, v103, v47
    v_add_f32 v96, v96, v48
    v_add_f32 v97, v97, v49
    v_add_f32 v98, v98, v50
    v_add_f32 v99, v99, v51
    v_add_f32 v100, v100, v52
    v_add_f32 v101, v101, v53
    v_add_f32 v102, v102, v54
    v_add_f32 v103, v103, v55
    v_cvt_pk_bf16_f32 v104, v96, v97
    v_cvt_pk_bf16_f32 v105, v98, v99
    v_cvt_pk_bf16_f32 v106, v100, v101
    v_cvt_pk_bf16_f32 v107, v102, v103
    s_cmp_eq_u32 s11, 2
    s_cbranch_scc1 L_KF_V
    buffer_store_dwordx4 v[104:107], v1, s[56:59], s7 offen offset:0 sc1
    v_mov_b32 v22, 0
    v_dot2_f32_bf16 v22, v104, v104, v22
    v_dot2_f32_bf16 v22, v105, v105, v22
    v_dot2_f32_bf16 v22, v106, v106, v22
    v_dot2_f32_bf16 v22, v107, v107, v22
    s_nop 2
    v_mov_b32 v23, v22
    s_nop 1
    v_permlane32_swap_b32 v22, v23
    s_nop 1
    v_add_f32 v14, v22, v23
    s_nop 1
    v_max_f32_dpp v14, v14, v14 row_shr:1 row_mask:0xf bank_mask:0xf bound_ctrl:0
    s_nop 1
    v_max_f32_dpp v14, v14, v14 row_shr:2 row_mask:0xf bank_mask:0xf bound_ctrl:0
    s_nop 1
    v_max_f32_dpp v14, v14, v14 row_shr:4 row_mask:0xf bank_mask:0xf bound_ctrl:0
    s_nop 1
    v_max_f32_dpp v14, v14, v14 row_shr:8 row_mask:0xf bank_mask:0xf bound_ctrl:0
    s_nop 1
    v_max_f32_dpp v14, v14, v14 row_bcast:15 row_mask:0xa bank_mask:0xf
    s_nop 1
    v_max_f32_dpp v14, v14, v14 row_bcast:31 row_mask:0xc bank_mask:0xf
    s_branch L_I2_X
L_KF_V:
    v_bfe_u32 v22, v0, 4, 1
    v_lshrrev_b32 v23, 5, v0
    v_lshl_add_u32 v22, v22, 1, v23
    v_and_b32 v23, 15, v0
    v_lshlrev_b32 v22, 8, v22
    v_lshl_add_u32 v22, v23, 4, v22
    buffer_store_dwordx4 v[104:107], v22, s[56:59], s7 offen offset:1024 sc1
    v_max3_f32 v25, |v96|, |v97|, |v98|
    v_max3_f32 v25, |v99|, |v100|, v25
    v_max3_f32 v25, |v101|, |v102|, v25
    v_max_f32 v25, |v103|, v25
    s_mov_b32 s8, 0x5d800000
    v_cmp_lt_f32 vcc, s8, v25
    s_nop 0
    s_cmp_lg_u64 vcc, 0
    s_cselect_b32 s8, 0x7f800000, 0
    v_mov_b32 v14, s8
L_I2_X:
L_I2_N:
    s_mov_b32 s78, 917504
    s_mul_i32 s79, s80, 4
    s_add_u32 m0, s74, 114688
    s_movk_i32 s6, 512
    buffer_load_dwordx4 v4, s[48:51], s78 offen lds
    s_add_u32 m0, s73, 98304
    s_nop 0
    buffer_load_dwordx4 v2, s[44:47], s6 offen lds
    s_add_u32 m0, s74, 115712
    s_nop 0
    buffer_load_dwordx4 v5, s[48:51], s78 offen lds
    s_add_u32 m0, s74, 116736
    s_movk_i32 s6, 512
    buffer_load_dwordx4 v6, s[48:51], s78 offen lds
    s_add_u32 m0, s73, 99328
    s_nop 0
    buffer_load_dwordx4 v3, s[44:47], s6 offen lds
    s_add_u32 m0, s74, 117760
    s_nop 0
    buffer_load_dwordx4 v7, s[48:51], s78 offen lds
    s_add_u32 m0, s74, 118784
    s_movk_i32 s6, 16896
    buffer_load_dwordx4 v8, s[52:55], s79 offen lds
    s_add_u32 m0, s73, 100352
    s_nop 0
    buffer_load_dwordx4 v2, s[44:47], s6 offen lds
    s_add_u32 m0, s74, 119808
    s_nop 0
    buffer_load_dwordx4 v9, s[52:55], s79 offen lds
    s_add_u32 m0, s74, 120832
    s_movk_i32 s6, 16896
    buffer_load_dwordx4 v10, s[68:71], s79 offen lds
    s_add_u32 m0, s73, 101376
    s_nop 0
    buffer_load_dwordx4 v3, s[44:47], s6 offen lds
    s_add_u32 m0, s74, 121856
    s_nop 0
    buffer_load_dwordx4 v11, s[68:71], s79 offen lds
    s_waitcnt vmcnt(12)
    s_cmp_eq_u32 s83, 0
    s_cbranch_scc1 L_KG_E
    s_lshl_b32 s6, s4, 2
    s_add_u32 s6, s6, s12
    s_lshl_b32 s6, s6, 1
    s_add_u32 s6, s6, s11
    s_lshl_b32 s6, s6, 7
    s_add_u32 s6, s6, 327552
    v_mov_b32 v15, s13
    v_mov_b32 v23, 0
    s_mov_b32 exec_lo, 0
    s_mov_b32 exec_hi, 0x80000000
    buffer_store_dwordx2 v[14:15], v23, s[56:59], s6 offen sc1
    s_mov_b64 exec, -1
L_KG_E:
    s_barrier
    s_cmp_lg_u32 s72, 1
    s_cbranch_scc1 L_I3_N
    v_and_b32 v22, 7, v0
    v_lshlrev_b32 v22, 2, v22
    v_add_u32 v22, 147456, v22
    ds_read_b32 v14, v22
    v_mov_b32 v15, s13
    v_lshlrev_b32 v22, 3, v0
    s_add_u32 s6, s42, 262144
    s_waitcnt lgkmcnt(0)
    s_mov_b64 exec, 0xff
    buffer_store_dwordx2 v[14:15], v22, s[56:59], s6 offen sc1
    s_mov_b64 exec, -1
    s_mov_b32 s83, 1
L_I3_N:
    s_mov_b32 s78, 1146880
    s_mul_i32 s79, s80, 5
    s_add_u32 m0, s74, 16384
    s_movk_i32 s6, 640
    buffer_load_dwordx4 v4, s[48:51], s78 offen lds
    s_add_u32 m0, s73, 0
    s_nop 0
    buffer_load_dwordx4 v2, s[44:47], s6 offen lds
    s_add_u32 m0, s74, 17408
    s_nop 0
    buffer_load_dwordx4 v5, s[48:51], s78 offen lds
    s_add_u32 m0, s74, 18432
    s_movk_i32 s6, 640
    buffer_load_dwordx4 v6, s[48:51], s78 offen lds
    s_add_u32 m0, s73, 1024
    s_nop 0
    buffer_load_dwordx4 v3, s[44:47], s6 offen lds
    s_add_u32 m0, s74, 19456
    s_nop 0
    buffer_load_dwordx4 v7, s[48:51], s78 offen lds
    s_add_u32 m0, s74, 20480
    s_movk_i32 s6, 17024
    buffer_load_dwordx4 v8, s[52:55], s79 offen lds
    s_add_u32 m0, s73, 2048
    s_nop 0
    buffer_load_dwordx4 v2, s[44:47], s6 offen lds
    s_add_u32 m0, s74, 21504
    s_nop 0
    buffer_load_dwordx4 v9, s[52:55], s79 offen lds
    s_add_u32 m0, s74, 22528
    s_movk_i32 s6, 17024
    buffer_load_dwordx4 v10, s[68:71], s79 offen lds
    s_add_u32 m0, s73, 3072
    s_nop 0
    buffer_load_dwordx4 v3, s[44:47], s6 offen lds
    s_add_u32 m0, s74, 23552
    s_nop 0
    buffer_load_dwordx4 v11, s[68:71], s79 offen lds
    s_waitcnt vmcnt(13)
    s_cmp_lg_u32 s83, 0
    s_cbranch_scc1 L_I3_E
    s_waitcnt vmcnt(12)
L_I3_E:
    s_barrier
    s_mov_b32 s78, 1376256
    s_mul_i32 s79, s80, 6
    s_add_u32 m0, s74, 65536
    s_movk_i32 s6, 768
    buffer_load_dwordx4 v4, s[48:51], s78 offen lds
    s_add_u32 m0, s73, 49152
    s_nop 0
    buffer_load_dwordx4 v2, s[44:47], s6 offen lds
    s_add_u32 m0, s74, 66560
    s_nop 0
    buffer_load_dwordx4 v5, s[48:51], s78 offen lds
    s_add_u32 m0, s74, 67584
    s_movk_i32 s6, 768
    buffer_load_dwordx4 v6, s[48:51], s78 offen lds
    s_add_u32 m0, s73, 50176
    s_nop 0
    buffer_load_dwordx4 v3, s[44:47], s6 offen lds
    s_add_u32 m0, s74, 68608
    s_nop 0
    buffer_load_dwordx4 v7, s[48:51], s78 offen lds
    s_add_u32 m0, s74, 69632
    s_movk_i32 s6, 17152
    buffer_load_dwordx4 v8, s[52:55], s79 offen lds
    s_add_u32 m0, s73, 51200
    s_nop 0
    buffer_load_dwordx4 v2, s[44:47], s6 offen lds
    s_add_u32 m0, s74, 70656
    s_nop 0
    buffer_load_dwordx4 v9, s[52:55], s79 offen lds
    s_add_u32 m0, s74, 71680
    s_movk_i32 s6, 17152
    buffer_load_dwordx4 v10, s[68:71], s79 offen lds
    s_add_u32 m0, s73, 52224
    s_nop 0
    buffer_load_dwordx4 v3, s[44:47], s6 offen lds
    s_add_u32 m0, s74, 72704
    s_nop 0
    buffer_load_dwordx4 v11, s[68:71], s79 offen lds
    s_waitcnt vmcnt(12)
    s_barrier
    s_mov_b32 s78, 1605632
    s_mul_i32 s79, s80, 7
    s_add_u32 m0, s74, 114688
    s_movk_i32 s6, 896
    buffer_load_dwordx4 v4, s[48:51], s78 offen lds
    s_add_u32 m0, s73, 98304
    s_nop 0
    buffer_load_dwordx4 v2, s[44:47], s6 offen lds
    s_add_u32 m0, s74, 115712
    s_nop 0
    buffer_load_dwordx4 v5, s[48:51], s78 offen lds
    s_add_u32 m0, s74, 116736
    s_movk_i32 s6, 896
    buffer_load_dwordx4 v6, s[48:51], s78 offen lds
    s_add_u32 m0, s73, 99328
    s_nop 0
    buffer_load_dwordx4 v3, s[44:47], s6 offen lds
    s_add_u32 m0, s74, 117760
    s_nop 0
    buffer_load_dwordx4 v7, s[48:51], s78 offen lds
    s_add_u32 m0, s74, 118784
    s_movk_i32 s6, 17280
    buffer_load_dwordx4 v8, s[52:55], s79 offen lds
    s_add_u32 m0, s73, 100352
    s_nop 0
    buffer_load_dwordx4 v2, s[44:47], s6 offen lds
    s_add_u32 m0, s74, 119808
    s_nop 0
    buffer_load_dwordx4 v9, s[52:55], s79 offen lds
    s_add_u32 m0, s74, 120832
    s_movk_i32 s6, 17280
    buffer_load_dwordx4 v10, s[68:71], s79 offen lds
    s_add_u32 m0, s73, 101376
    s_nop 0
    buffer_load_dwordx4 v3, s[44:47], s6 offen lds
    s_add_u32 m0, s74, 121856
    s_nop 0
    buffer_load_dwordx4 v11, s[68:71], s79 offen lds
    s_waitcnt vmcnt(12)
    s_barrier
    s_cmp_lg_u32 s72, 2
    s_cbranch_scc1 L_EC_X
    v_lshlrev_b32 v25, 8, v0
    s_mov_b32 s86, 327680
    s_mov_b32 s26, 0
L_EC_L:
    buffer_load_dwordx2 v[14:15], v25, s[56:59], s86 offen sc1
    buffer_load_dwordx2 v[16:17], v25, s[56:59], s86 offen offset:128 sc1
    s_waitcnt vmcnt(0)
    v_cmp_ne_u32 vcc, s13, v15
    v_cmp_ne_u32 s[6:7], s13, v17
    s_or_b64 vcc, vcc, s[6:7]
    s_cbranch_scc0 L_EC_E
    s_add_u32 s26, s26, 1
    s_cmp_ge_u32 s26, 16384
    s_cbranch_scc1 L_EC_E
    s_sleep 2
    s_branch L_EC_L
L_EC_E:
    v_max_f32 v22, v14, v16
    s_nop 1
    v_max_f32_dpp v22, v22, v22 row_shr:1 row_mask:0xf bank_mask:0xf bound_ctrl:0
    s_nop 1
    v_max_f32_dpp v22, v22, v22 row_shr:2 row_mask:0xf bank_mask:0xf bound_ctrl:0
    s_nop 1
    v_max_f32_dpp v22, v22, v22 row_shr:4 row_mask:0xf bank_mask:0xf bound_ctrl:0
    s_nop 1
    v_max_f32_dpp v22, v22, v22 row_shr:8 row_mask:0xf bank_mask:0xf bound_ctrl:0
    s_nop 1
    v_max_f32_dpp v22, v22, v22 row_bcast:15 row_mask:0xa bank_mask:0xf
    s_nop 1
    v_max_f32_dpp v22, v22, v22 row_bcast:31 row_mask:0xc bank_mask:0xf
    v_mov_b32 v23, 147520
    s_mov_b32 exec_lo, 0
    s_mov_b32 exec_hi, 0x80000000
    ds_write_b32 v23, v22
    s_mov_b64 exec, -1
    s_waitcnt lgkmcnt(0)
L_EC_X:
    s_cmp_lg_u32 s72, 3
    s_cbranch_scc1 L_GP_X
    v_lshrrev_b32 v24, 3, v0
    v_and_b32 v22, 7, v0
    v_lshlrev_b32 v24, 7, v24
    v_lshl_add_u32 v24, v22, 3, v24
    s_lshl_b32 s7, s4, 11
    s_add_u32 s87, s7, 262144
    s_mov_b32 s26, 0
L_GP_L:
    buffer_load_dwordx2 v[14:15], v24, s[56:59], s87 offen sc1
    buffer_load_dwordx2 v[16:17], v24, s[56:59], s87 offen offset:1024 sc1
    s_waitcnt vmcnt(0)
    v_cmp_ne_u32 vcc, s13, v15
    v_cmp_ne_u32 s[6:7], s13, v17
    s_or_b64 vcc, vcc, s[6:7]
    s_cbranch_scc0 L_GP_E
    s_add_u32 s26, s26, 1
    s_cmp_ge_u32 s26, 16384
    s_cbranch_scc1 L_GP_E
    s_sleep 1
    s_branch L_GP_L
L_GP_E:
    v_lshlrev_b32 v22, 2, v0
    v_add_u32 v22, 148480, v22
    ds_write_b32 v22, v14
    ds_write_b32 v22, v16 offset:256
L_GP_X:
    s_waitcnt vmcnt(0) lgkmcnt(0)
    s_barrier
    s_add_u32 m0, s27, 0
    s_add_u32 s78, s27, 0
    buffer_load_dwordx4 v1, s[56:59], s78 offen sc1 lds
    s_add_u32 m0, s27, 4096
    s_add_u32 s78, s27, 4096
    buffer_load_dwordx4 v1, s[56:59], s78 offen sc1 lds
    s_add_u32 m0, s27, 8192
    s_add_u32 s78, s27, 8192
    buffer_load_dwordx4 v1, s[56:59], s78 offen sc1 lds
    s_add_u32 m0, s27, 12288
    s_add_u32 s78, s27, 12288
    buffer_load_dwordx4 v1, s[56:59], s78 offen sc1 lds
    s_add_u32 m0, s27, 16384
    s_add_u32 s78, s27, 16384
    buffer_load_dwordx4 v1, s[56:59], s78 offen sc1 lds
    s_add_u32 m0, s27, 20480
    s_add_u32 s78, s27, 20480
    buffer_load_dwordx4 v1, s[56:59], s78 offen sc1 lds
    s_add_u32 m0, s27, 24576
    s_add_u32 s78, s27, 24576
    buffer_load_dwordx4 v1, s[56:59], s78 offen sc1 lds
    s_add_u32 m0, s27, 28672
    s_add_u32 s78, s27, 28672
    buffer_load_dwordx4 v1, s[56:59], s78 offen sc1 lds
    s_add_u32 m0, s27, 32768
    s_add_u32 s78, s27, 32768
    buffer_load_dwordx4 v1, s[56:59], s78 offen sc1 lds
    s_add_u32 m0, s27, 36864
    s_add_u32 s78, s27, 36864
    buffer_load_dwordx4 v1, s[56:59], s78 offen sc1 lds
    s_add_u32 m0, s27, 40960
    s_add_u32 s78, s27, 40960
    buffer_load_dwordx4 v1, s[56:59], s78 offen sc1 lds
    s_add_u32 m0, s27, 45056
    s_add_u32 s78, s27, 45056
    buffer_load_dwordx4 v1, s[56:59], s78 offen sc1 lds
    v_mov_b32 v64, 0
    v_mov_b32 v65, 0
    v_mov_b32 v66, 0
    v_mov_b32 v67, 0
    v_mov_b32 v68, 0
    v_mov_b32 v69, 0
    v_mov_b32 v70, 0
    v_mov_b32 v71, 0
    v_mov_b32 v72, 0
    v_mov_b32 v73, 0
    v_mov_b32 v74, 0
    v_mov_b32 v75, 0
    v_mov_b32 v76, 0
    v_mov_b32 v77, 0
    v_mov_b32 v78, 0
    v_mov_b32 v79, 0
    v_mov_b32 v80, 0
    v_mov_b32 v81, 0
    v_mov_b32 v82, 0
    v_mov_b32 v83, 0
    v_mov_b32 v84, 0
    v_mov_b32 v85, 0
    v_mov_b32 v86, 0
    v_mov_b32 v87, 0
    v_mov_b32 v88, 0
    v_mov_b32 v89, 0
    v_mov_b32 v90, 0
    v_mov_b32 v91, 0
    v_mov_b32 v92, 0
    v_mov_b32 v93, 0
    v_mov_b32 v94, 0
    v_mov_b32 v95, 0
    v_mov_b32 v96, 0
    v_mov_b32 v97, 0
    v_mov_b32 v98, 0
    v_mov_b32 v99, 0
    v_mov_b32 v100, 0
    v_mov_b32 v101, 0
    v_mov_b32 v102, 0
    v_mov_b32 v103, 0
    v_mov_b32 v104, 0
    v_mov_b32 v105, 0
    v_mov_b32 v106, 0
    v_mov_b32 v107, 0
    v_mov_b32 v108, 0
    v_mov_b32 v109, 0
    v_mov_b32 v110, 0
    v_mov_b32 v111, 0
    v_mov_b32 v112, 0
    v_mov_b32 v113, 0
    v_mov_b32 v114, 0
    v_mov_b32 v115, 0
    v_mov_b32 v116, 0
    v_mov_b32 v117, 0
    v_mov_b32 v118, 0
    v_mov_b32 v119, 0
    v_mov_b32 v120, 0
    v_mov_b32 v121, 0
    v_mov_b32 v122, 0
    v_mov_b32 v123, 0
    v_mov_b32 v124, 0
    v_mov_b32 v125, 0
    v_mov_b32 v126, 0
    v_mov_b32 v127, 0
    v_bfe_u32 v22, v0, 4, 1
    v_and_b32 v23, 7, v0
    v_lshlrev_b32 v22, 2, v22
    v_xor_b32 v22, v22, v23
    v_lshrrev_b32 v23, 3, v0
    v_lshlrev_b32 v23, 10, v23
    v_lshl_add_u32 v22, v22, 4, v23
    s_lshl_b32 s6, s72, 14
    s_lshl_b32 s7, s15, 7
    s_add_u32 s6, s6, s7
    v_add_u32 v2, s6, v22
    v_lshrrev_b32 v21, 5, v0
    v_bfe_u32 v22, v0, 2, 2
    v_lshl_add_u32 v23, v21, 2, v22
    v_lshlrev_b32 v23, 7, v23
    v_bfe_u32 v22, v0, 3, 1
    v_lshl_add_u32 v23, v22, 6, v23
    v_bfe_u32 v22, v0, 4, 1
    v_lshl_add_u32 v23, v22, 5, v23
    v_and_b32 v22, 3, v0
    v_lshl_add_u32 v23, v22, 3, v23
    s_add_u32 s75, s74, 131072
    v_add_u32 v5, s75, v23
    v_xor_b32 v6, 64, v5
    s_mul_i32 s6, s14, 288
    s_add_u32 s6, s6, s72
    s_lshl_b32 s6, s6, 10
    s_add_u32 s6, s6, 2097152
    v_add_u32 v3, s6, v1
    v_add_u32 v4, 147456, v3
    v_and_b32 v7, 15, v0
    v_lshlrev_b32 v7, 7, v7
    s_mov_b32 s48, s32
    s_mov_b32 s49, s33
    s_mov_b32 s50, 0x1c0000
    s_mov_b32 s51, 0x20000
    s_mov_b32 s52, s24
    s_mov_b32 s53, s25
    s_mov_b32 s54, 0x80000
    s_mov_b32 s55, 0x20000
    s_waitcnt vmcnt(0)
    s_barrier
    s_add_u32 m0, s27, 49152
    s_add_u32 s78, s27, 49152
    buffer_load_dwordx4 v1, s[56:59], s78 offen sc1 lds
    s_add_u32 m0, s27, 53248
    s_add_u32 s78, s27, 53248
    buffer_load_dwordx4 v1, s[56:59], s78 offen sc1 lds
    s_add_u32 m0, s27, 57344
    s_add_u32 s78, s27, 57344
    buffer_load_dwordx4 v1, s[56:59], s78 offen sc1 lds
    s_add_u32 m0, s27, 61440
    s_add_u32 s78, s27, 61440
    buffer_load_dwordx4 v1, s[56:59], s78 offen sc1 lds
    s_add_u32 m0, s27, 65536
    s_add_u32 s78, s27, 65536
    buffer_load_dwordx4 v1, s[56:59], s78 offen sc1 lds
    s_add_u32 m0, s27, 69632
    s_add_u32 s78, s27, 69632
    buffer_load_dwordx4 v1, s[56:59], s78 offen sc1 lds
    s_add_u32 m0, s27, 73728
    s_add_u32 s78, s27, 73728
    buffer_load_dwordx4 v1, s[56:59], s78 offen sc1 lds
    s_add_u32 m0, s27, 77824
    s_add_u32 s78, s27, 77824
    buffer_load_dwordx4 v1, s[56:59], s78 offen sc1 lds
    s_add_u32 m0, s27, 81920
    s_add_u32 s78, s27, 81920
    buffer_load_dwordx4 v1, s[56:59], s78 offen sc1 lds
    s_add_u32 m0, s27, 86016
    s_add_u32 s78, s27, 86016
    buffer_load_dwordx4 v1, s[56:59], s78 offen sc1 lds
    s_add_u32 m0, s27, 90112
    s_add_u32 s78, s27, 90112
    buffer_load_dwordx4 v1, s[56:59], s78 offen sc1 lds
    s_add_u32 m0, s27, 94208
    s_add_u32 s78, s27, 94208
    buffer_load_dwordx4 v1, s[56:59], s78 offen sc1 lds
    s_add_u32 m0, s27, 98304
    s_add_u32 s78, s27, 98304
    buffer_load_dwordx4 v1, s[56:59], s78 offen sc1 lds
    s_add_u32 m0, s27, 102400
    s_add_u32 s78, s27, 102400
    buffer_load_dwordx4 v1, s[56:59], s78 offen sc1 lds
    s_add_u32 m0, s27, 106496
    s_add_u32 s78, s27, 106496
    buffer_load_dwordx4 v1, s[56:59], s78 offen sc1 lds
    s_add_u32 m0, s27, 110592
    s_add_u32 s78, s27, 110592
    buffer_load_dwordx4 v1, s[56:59], s78 offen sc1 lds
    s_add_u32 m0, s27, 114688
    s_add_u32 s78, s27, 114688
    buffer_load_dwordx4 v1, s[56:59], s78 offen sc1 lds
    s_add_u32 m0, s27, 118784
    s_add_u32 s78, s27, 118784
    buffer_load_dwordx4 v1, s[56:59], s78 offen sc1 lds
    s_add_u32 m0, s27, 122880
    s_add_u32 s78, s27, 122880
    buffer_load_dwordx4 v1, s[56:59], s78 offen sc1 lds
    s_add_u32 m0, s27, 126976
    s_add_u32 s78, s27, 126976
    buffer_load_dwordx4 v1, s[56:59], s78 offen sc1 lds
    s_mul_i32 s6, s2, 7168
    s_lshl_b32 s7, s72, 11
    s_add_u32 s6, s6, s7
    buffer_load_dwordx4 v[160:163], v1, s[48:51], s6 offen
    buffer_load_dwordx4 v[160:163], v1, s[48:51], s6 offen offset:1024
    s_lshl_b32 s6, s2, 11
    s_lshl_b32 s7, s72, 9
    s_add_u32 s6, s6, s7
    s_mov_b64 exec, 0xffffffff
    buffer_load_dwordx4 v[160:163], v1, s[52:55], s6 offen
    s_mov_b64 exec, -1
    s_waitcnt vmcnt(0)
    s_barrier
    s_setprio 0
    s_cmp_lg_u32 s72, 0
    s_cbranch_scc1 L_NOHF
    v_mov_b32 v24, 0
    v_mov_b32 v23, s13
    s_add_u32 s6, s42, 393216
    s_mov_b64 exec, 1
    buffer_store_dword v23, v24, s[56:59], s6 offen sc1
    s_mov_b64 exec, -1
L_NOHF:
    s_lshl_b32 s87, s72, 14
    s_add_u32 m0, s75, 0
    s_add_u32 s6, s87, 0
    buffer_load_dwordx4 v2, s[52:55], s6 offen lds
    s_add_u32 m0, s75, 1024
    s_add_u32 s6, s87, 8192
    buffer_load_dwordx4 v2, s[52:55], s6 offen lds
    s_add_u32 m0, s75, 2048
    s_add_u32 s6, s87, 131072
    buffer_load_dwordx4 v2, s[52:55], s6 offen lds
    s_add_u32 m0, s75, 3072
    s_add_u32 s6, s87, 139264
    buffer_load_dwordx4 v2, s[52:55], s6 offen lds
    s_add_u32 m0, s75, 4096
    s_add_u32 s6, s87, 262144
    buffer_load_dwordx4 v2, s[52:55], s6 offen lds
    s_add_u32 m0, s75, 5120
    s_add_u32 s6, s87, 270336
    buffer_load_dwordx4 v2, s[52:55], s6 offen lds
    s_add_u32 m0, s75, 6144
    s_add_u32 s6, s87, 393216
    buffer_load_dwordx4 v2, s[52:55], s6 offen lds
    s_add_u32 m0, s75, 7168
    s_add_u32 s6, s87, 401408
    buffer_load_dwordx4 v2, s[52:55], s6 offen lds
    s_waitcnt vmcnt(0)
    ds_read_b64_tr_b16 v[128:129], v5 offset:0
    ds_read_b64_tr_b16 v[130:131], v5 offset:1024
    ds_read_b64_tr_b16 v[132:133], v6 offset:0
    ds_read_b64_tr_b16 v[134:135], v6 offset:1024
    s_waitcnt lgkmcnt(4)
    ds_read_b64_tr_b16 v[136:137], v5 offset:2048
    ds_read_b64_tr_b16 v[138:139], v5 offset:3072
    ds_read_b64_tr_b16 v[140:141], v6 offset:2048
    ds_read_b64_tr_b16 v[142:143], v6 offset:3072
    s_waitcnt lgkmcnt(4)
    ds_read_b64_tr_b16 v[144:145], v5 offset:4096
    ds_read_b64_tr_b16 v[146:147], v5 offset:5120
    ds_read_b64_tr_b16 v[148:149], v6 offset:4096
    ds_read_b64_tr_b16 v[150:151], v6 offset:5120
    s_waitcnt lgkmcnt(4)
    ds_read_b64_tr_b16 v[152:153], v5 offset:6144
    ds_read_b64_tr_b16 v[154:155], v5 offset:7168
    ds_read_b64_tr_b16 v[156:157], v6 offset:6144
    ds_read_b64_tr_b16 v[158:159], v6 offset:7168
    s_waitcnt lgkmcnt(4)
    s_waitcnt lgkmcnt(0)
    s_lshr_b32 s6, s14, 1
    s_lshl_b32 s6, s6, 11
    s_add_u32 s78, s6, 393216
    s_mov_b32 s26, 0
L_HP_L:
    buffer_load_dword v8, v7, s[56:59], s78 offen sc1
    s_waitcnt vmcnt(0)
    v_cmp_ne_u32 vcc, s13, v8
    s_cmp_eq_u64 vcc, 0
    s_cbranch_scc1 L_HP_E
    s_add_u32 s26, s26, 1
    s_cmp_ge_u32 s26, 16384
    s_cbranch_scc1 L_HP_E
    s_sleep 4
    s_branch L_HP_L
L_HP_E:
    s_mov_b32 s79, 0
    s_mov_b32 s86, 32768
    s_add_u32 m0, s75, 0
    s_add_u32 s6, s79, 0
    buffer_load_dwordx4 v2, s[48:51], s6 offen lds
    s_add_u32 m0, s75, 1024
    s_add_u32 s6, s79, 8192
    buffer_load_dwordx4 v2, s[48:51], s6 offen lds
    s_add_u32 s6, s86, 0
    buffer_load_dwordx4 v[32:35], v3, s[56:59], s6 offen sc1
    buffer_load_dwordx4 v[36:39], v4, s[56:59], s6 offen sc1
    s_add_u32 m0, s75, 2048
    s_add_u32 s6, s79, 65536
    buffer_load_dwordx4 v2, s[48:51], s6 offen lds
    s_add_u32 m0, s75, 3072
    s_add_u32 s6, s79, 73728
    buffer_load_dwordx4 v2, s[48:51], s6 offen lds
    s_add_u32 s6, s86, 4096
    buffer_load_dwordx4 v[40:43], v3, s[56:59], s6 offen sc1
    buffer_load_dwordx4 v[44:47], v4, s[56:59], s6 offen sc1
    s_add_u32 m0, s75, 4096
    s_add_u32 s6, s79, 131072
    buffer_load_dwordx4 v2, s[48:51], s6 offen lds
    s_add_u32 m0, s75, 5120
    s_add_u32 s6, s79, 139264
    buffer_load_dwordx4 v2, s[48:51], s6 offen lds
    s_add_u32 s6, s86, 8192
    buffer_load_dwordx4 v[48:51], v3, s[56:59], s6 offen sc1
    buffer_load_dwordx4 v[52:55], v4, s[56:59], s6 offen sc1
    s_add_u32 m0, s75, 6144
    s_add_u32 s6, s79, 196608
    buffer_load_dwordx4 v2, s[48:51], s6 offen lds
    s_add_u32 m0, s75, 7168
    s_add_u32 s6, s79, 204800
    buffer_load_dwordx4 v2, s[48:51], s6 offen lds
    s_add_u32 s6, s86, 12288
    buffer_load_dwordx4 v[56:59], v3, s[56:59], s6 offen sc1
    buffer_load_dwordx4 v[60:63], v4, s[56:59], s6 offen sc1
    s_mov_b32 s82, 0
L_FFN:
    s_waitcnt vmcnt(12)
    ds_read_b64_tr_b16 v[24:25], v5 offset:0
    ds_read_b64_tr_b16 v[26:27], v5 offset:1024
    ds_read_b64_tr_b16 v[28:29], v6 offset:0
    ds_read_b64_tr_b16 v[30:31], v6 offset:1024
    s_waitcnt lgkmcnt(0)
    v_mfma_f32_32x32x16_bf16 v[64:79], v[24:27], v[32:35], v[64:79]
    s_add_u32 m0, s75, 0
    s_add_u32 s6, s79, 262144
    buffer_load_dwordx4 v2, s[48:51], s6 offen lds
    v_mfma_f32_32x32x16_bf16 v[96:111], v[28:31], v[32:35], v[96:111]
    s_add_u32 m0, s75, 1024
    s_add_u32 s6, s79, 270336
    buffer_load_dwordx4 v2, s[48:51], s6 offen lds
    v_mfma_f32_32x32x16_bf16 v[80:95], v[24:27], v[36:39], v[80:95]
    s_add_u32 s6, s86, 16384
    buffer_load_dwordx4 v[32:35], v3, s[56:59], s6 offen sc1
    v_mfma_f32_32x32x16_bf16 v[112:127], v[28:31], v[36:39], v[112:127]
    buffer_load_dwordx4 v[36:39], v4, s[56:59], s6 offen sc1
    s_waitcnt vmcnt(12)
    ds_read_b64_tr_b16 v[24:25], v5 offset:2048
    ds_read_b64_tr_b16 v[26:27], v5 offset:3072
    ds_read_b64_tr_b16 v[28:29], v6 offset:2048
    ds_read_b64_tr_b16 v[30:31], v6 offset:3072
    s_waitcnt lgkmcnt(0)
    v_mfma_f32_32x32x16_bf16 v[64:79], v[24:27], v[40:43], v[64:79]
    s_add_u32 m0, s75, 2048
    s_add_u32 s6, s79, 327680
    buffer_load_dwordx4 v2, s[48:51], s6 offen lds
    v_mfma_f32_32x32x16_bf16 v[96:111], v[28:31], v[40:43], v[96:111]
    s_add_u32 m0, s75, 3072
    s_add_u32 s6, s79, 335872
    buffer_load_dwordx4 v2, s[48:51], s6 offen lds
    v_mfma_f32_32x32x16_bf16 v[80:95], v[24:27], v[44:47], v[80:95]
    s_add_u32 s6, s86, 20480
    buffer_load_dwordx4 v[40:43], v3, s[56:59], s6 offen sc1
    v_mfma_f32_32x32x16_bf16 v[112:127], v[28:31], v[44:47], v[112:127]
    buffer_load_dwordx4 v[44:47], v4, s[56:59], s6 offen sc1
    s_waitcnt vmcnt(12)
    ds_read_b64_tr_b16 v[24:25], v5 offset:4096
    ds_read_b64_tr_b16 v[26:27], v5 offset:5120
    ds_read_b64_tr_b16 v[28:29], v6 offset:4096
    ds_read_b64_tr_b16 v[30:31], v6 offset:5120
    s_waitcnt lgkmcnt(0)
    v_mfma_f32_32x32x16_bf16 v[64:79], v[24:27], v[48:51], v[64:79]
    s_add_u32 m0, s75, 4096
    s_add_u32 s6, s79, 393216
    buffer_load_dwordx4 v2, s[48:51], s6 offen lds
    v_mfma_f32_32x32x16_bf16 v[96:111], v[28:31], v[48:51], v[96:111]
    s_add_u32 m0, s75, 5120
    s_add_u32 s6, s79, 401408
    buffer_load_dwordx4 v2, s[48:51], s6 offen lds
    v_mfma_f32_32x32x16_bf16 v[80:95], v[24:27], v[52:55], v[80:95]
    s_add_u32 s6, s86, 24576
    buffer_load_dwordx4 v[48:51], v3, s[56:59], s6 offen sc1
    v_mfma_f32_32x32x16_bf16 v[112:127], v[28:31], v[52:55], v[112:127]
    buffer_load_dwordx4 v[52:55], v4, s[56:59], s6 offen sc1
    s_waitcnt vmcnt(12)
    ds_read_b64_tr_b16 v[24:25], v5 offset:6144
    ds_read_b64_tr_b16 v[26:27], v5 offset:7168
    ds_read_b64_tr_b16 v[28:29], v6 offset:6144
    ds_read_b64_tr_b16 v[30:31], v6 offset:7168
    s_waitcnt lgkmcnt(0)
    v_mfma_f32_32x32x16_bf16 v[64:79], v[24:27], v[56:59], v[64:79]
    s_add_u32 m0, s75, 6144
    s_add_u32 s6, s79, 458752
    buffer_load_dwordx4 v2, s[48:51], s6 offen lds
    v_mfma_f32_32x32x16_bf16 v[96:111], v[28:31], v[56:59], v[96:111]
    s_add_u32 m0, s75, 7168
    s_add_u32 s6, s79, 466944
    buffer_load_dwordx4 v2, s[48:51], s6 offen lds
    v_mfma_f32_32x32x16_bf16 v[80:95], v[24:27], v[60:63], v[80:95]
    s_add_u32 s6, s86, 28672
    buffer_load_dwordx4 v[56:59], v3, s[56:59], s6 offen sc1
    v_mfma_f32_32x32x16_bf16 v[112:127], v[28:31], v[60:63], v[112:127]
    buffer_load_dwordx4 v[60:63], v4, s[56:59], s6 offen sc1
    s_add_u32 s79, s79, 262144
    s_add_u32 s86, s86, 16384
    s_add_u32 s82, s82, 1
    s_cmp_lt_u32 s82, 7
    s_cbranch_scc1 L_FFN
    s_waitcnt vmcnt(0)
    s_add_u32 m0, s75, 0
    s_add_u32 s6, s87, 16384
    buffer_load_dwordx4 v2, s[52:55], s6 offen lds
    s_add_u32 m0, s75, 1024
    s_add_u32 s6, s87, 24576
    buffer_load_dwordx4 v2, s[52:55], s6 offen lds
    s_add_u32 m0, s75, 2048
    s_add_u32 s6, s87, 147456
    buffer_load_dwordx4 v2, s[52:55], s6 offen lds
    s_add_u32 m0, s75, 3072
    s_add_u32 s6, s87, 155648
    buffer_load_dwordx4 v2, s[52:55], s6 offen lds
    s_add_u32 m0, s75, 4096
    s_add_u32 s6, s87, 278528
    buffer_load_dwordx4 v2, s[52:55], s6 offen lds
    s_add_u32 m0, s75, 5120
    s_add_u32 s6, s87, 286720
    buffer_load_dwordx4 v2, s[52:55], s6 offen lds
    s_add_u32 m0, s75, 6144
    s_add_u32 s6, s87, 409600
    buffer_load_dwordx4 v2, s[52:55], s6 offen lds
    s_add_u32 m0, s75, 7168
    s_add_u32 s6, s87, 417792
    buffer_load_dwordx4 v2, s[52:55], s6 offen lds
    v_and_b32 v21, 31, v0
    v_lshrrev_b32 v22, 5, v0
    v_and_b32 v24, 15, v0
    v_xor_b32 v22, v22, v24
    v_lshlrev_b32 v21, 8, v21
    v_lshl_add_u32 v21, v22, 4, v21
    s_lshl_b32 s7, s72, 14
    v_add_u32 v21, s7, v21
    v_xor_b32 v9, 0, v21
    v_xor_b32 v10, 32, v21
    v_xor_b32 v11, 64, v21
    v_xor_b32 v12, 96, v21
    v_xor_b32 v13, 128, v21
    v_xor_b32 v14, 160, v21
    v_xor_b32 v15, 192, v21
    v_xor_b32 v16, 224, v21
    s_lshl_b32 s86, s72, 10
    s_mov_b32 s26, 0
L_OP0_L:
    s_add_u32 s6, s86, 0
    buffer_load_dwordx4 v[32:35], v3, s[56:59], s6 offen sc1
    buffer_load_dwordx4 v[36:39], v4, s[56:59], s6 offen sc1
    s_add_u32 s6, s86, 8192
    buffer_load_dwordx4 v[40:43], v3, s[56:59], s6 offen sc1
    buffer_load_dwordx4 v[44:47], v4, s[56:59], s6 offen sc1
    s_add_u32 s6, s86, 16384
    buffer_load_dwordx4 v[48:51], v3, s[56:59], s6 offen sc1
    buffer_load_dwordx4 v[52:55], v4, s[56:59], s6 offen sc1
    s_add_u32 s6, s86, 24576
    buffer_load_dwordx4 v[56:59], v3, s[56:59], s6 offen sc1
    buffer_load_dwordx4 v[60:63], v4, s[56:59], s6 offen sc1
    s_waitcnt vmcnt(0)
    v_max3_u32 v21, v32, v33, v34
    v_max3_u32 v22, v35, v36, v37
    v_max3_u32 v21, v38, v39, v21
    v_max3_u32 v22, v40, v41, v22
    v_max3_u32 v21, v42, v43, v21
    v_max3_u32 v22, v44, v45, v22
    v_max3_u32 v21, v46, v47, v21
    v_max3_u32 v22, v48, v49, v22
    v_max3_u32 v21, v50, v51, v21
    v_max3_u32 v22, v52, v53, v22
    v_max3_u32 v21, v54, v55, v21
    v_max3_u32 v22, v56, v57, v22
    v_max3_u32 v21, v58, v59, v21
    v_max3_u32 v22, v60, v61, v22
    v_max3_u32 v21, v62, v63, v21
    v_max_u32 v21, v21, v22
    v_cmp_eq_u32 vcc, -1, v21
    s_cmp_eq_u64 vcc, 0
    s_cbranch_scc1 L_OP0_E
    s_add_u32 s26, s26, 1
    s_cmp_ge_u32 s26, 16384
    s_cbranch_scc1 L_OP0_E
    s_sleep 8
    s_branch L_OP0_L
L_OP0_E:
    v_mfma_f32_32x32x16_bf16 v[64:79], v[128:131], v[32:35], v[64:79]
    v_mfma_f32_32x32x16_bf16 v[80:95], v[128:131], v[36:39], v[80:95]
    v_mfma_f32_32x32x16_bf16 v[96:111], v[132:135], v[32:35], v[96:111]
    v_mfma_f32_32x32x16_bf16 v[112:127], v[132:135], v[36:39], v[112:127]
    v_mfma_f32_32x32x16_bf16 v[64:79], v[136:139], v[40:43], v[64:79]
    v_mfma_f32_32x32x16_bf16 v[80:95], v[136:139], v[44:47], v[80:95]
    v_mfma_f32_32x32x16_bf16 v[96:111], v[140:143], v[40:43], v[96:111]
    v_mfma_f32_32x32x16_bf16 v[112:127], v[140:143], v[44:47], v[112:127]
    v_mfma_f32_32x32x16_bf16 v[64:79], v[144:147], v[48:51], v[64:79]
    v_mfma_f32_32x32x16_bf16 v[80:95], v[144:147], v[52:55], v[80:95]
    v_mfma_f32_32x32x16_bf16 v[96:111], v[148:151], v[48:51], v[96:111]
    v_mfma_f32_32x32x16_bf16 v[112:127], v[148:151], v[52:55], v[112:127]
    v_mfma_f32_32x32x16_bf16 v[64:79], v[152:155], v[56:59], v[64:79]
    v_mfma_f32_32x32x16_bf16 v[80:95], v[152:155], v[60:63], v[80:95]
    v_mfma_f32_32x32x16_bf16 v[96:111], v[156:159], v[56:59], v[96:111]
    v_mfma_f32_32x32x16_bf16 v[112:127], v[156:159], v[60:63], v[112:127]
    ds_read_b64_tr_b16 v[128:129], v5 offset:0
    ds_read_b64_tr_b16 v[130:131], v5 offset:1024
    ds_read_b64_tr_b16 v[132:133], v6 offset:0
    ds_read_b64_tr_b16 v[134:135], v6 offset:1024
    s_waitcnt lgkmcnt(4)
    ds_read_b64_tr_b16 v[136:137], v5 offset:2048
    ds_read_b64_tr_b16 v[138:139], v5 offset:3072
    ds_read_b64_tr_b16 v[140:141], v6 offset:2048
    ds_read_b64_tr_b16 v[142:143], v6 offset:3072
    s_waitcnt lgkmcnt(4)
    ds_read_b64_tr_b16 v[144:145], v5 offset:4096
    ds_read_b64_tr_b16 v[146:147], v5 offset:5120
    ds_read_b64_tr_b16 v[148:149], v6 offset:4096
    ds_read_b64_tr_b16 v[150:151], v6 offset:5120
    s_waitcnt lgkmcnt(4)
    ds_read_b64_tr_b16 v[152:153], v5 offset:6144
    ds_read_b64_tr_b16 v[154:155], v5 offset:7168
    ds_read_b64_tr_b16 v[156:157], v6 offset:6144
    ds_read_b64_tr_b16 v[158:159], v6 offset:7168
    s_waitcnt lgkmcnt(4)
    s_waitcnt lgkmcnt(0)
    s_setprio 3
    s_barrier
    s_mov_b32 s26, 0
L_OP1_L:
    s_add_u32 s6, s86, 1024
    buffer_load_dwordx4 v[32:35], v3, s[56:59], s6 offen sc1
    buffer_load_dwordx4 v[36:39], v4, s[56:59], s6 offen sc1
    s_add_u32 s6, s86, 9216
    buffer_load_dwordx4 v[40:43], v3, s[56:59], s6 offen sc1
    buffer_load_dwordx4 v[44:47], v4, s[56:59], s6 offen sc1
    s_add_u32 s6, s86, 17408
    buffer_load_dwordx4 v[48:51], v3, s[56:59], s6 offen sc1
    buffer_load_dwordx4 v[52:55], v4, s[56:59], s6 offen sc1
    s_add_u32 s6, s86, 25600
    buffer_load_dwordx4 v[56:59], v3, s[56:59], s6 offen sc1
    buffer_load_dwordx4 v[60:63], v4, s[56:59], s6 offen sc1
    s_waitcnt vmcnt(0)
    v_max3_u32 v21, v32, v33, v34
    v_max3_u32 v22, v35, v36, v37
    v_max3_u32 v21, v38, v39, v21
    v_max3_u32 v22, v40, v41, v22
    v_max3_u32 v21, v42, v43, v21
    v_max3_u32 v22, v44, v45, v22
    v_max3_u32 v21, v46, v47, v21
    v_max3_u32 v22, v48, v49, v22
    v_max3_u32 v21, v50, v51, v21
    v_max3_u32 v22, v52, v53, v22
    v_max3_u32 v21, v54, v55, v21
    v_max3_u32 v22, v56, v57, v22
    v_max3_u32 v21, v58, v59, v21
    v_max3_u32 v22, v60, v61, v22
    v_max3_u32 v21, v62, v63, v21
    v_max_u32 v21, v21, v22
    v_cmp_eq_u32 vcc, -1, v21
    s_cmp_eq_u64 vcc, 0
    s_cbranch_scc1 L_OP1_E
    s_add_u32 s26, s26, 1
    s_cmp_ge_u32 s26, 16384
    s_cbranch_scc1 L_OP1_E
    s_sleep 1
    s_branch L_OP1_L
L_OP1_E:
    v_mfma_f32_32x32x16_bf16 v[64:79], v[128:131], v[32:35], v[64:79]
    v_mfma_f32_32x32x16_bf16 v[64:79], v[136:139], v[40:43], v[64:79]
    v_mfma_f32_32x32x16_bf16 v[64:79], v[144:147], v[48:51], v[64:79]
    v_mfma_f32_32x32x16_bf16 v[64:79], v[152:155], v[56:59], v[64:79]
    v_mfma_f32_32x32x16_bf16 v[80:95], v[128:131], v[36:39], v[80:95]
    v_mfma_f32_32x32x16_bf16 v[80:95], v[136:139], v[44:47], v[80:95]
    v_mfma_f32_32x32x16_bf16 v[80:95], v[144:147], v[52:55], v[80:95]
    v_mfma_f32_32x32x16_bf16 v[80:95], v[152:155], v[60:63], v[80:95]
    s_nop 8
    ds_write_b128 v9, v[64:67] offset:0
    ds_write_b128 v10, v[68:71] offset:0
    ds_write_b128 v11, v[72:75] offset:0
    ds_write_b128 v12, v[76:79] offset:0
    v_mfma_f32_32x32x16_bf16 v[96:111], v[132:135], v[32:35], v[96:111]
    v_mfma_f32_32x32x16_bf16 v[96:111], v[140:143], v[40:43], v[96:111]
    v_mfma_f32_32x32x16_bf16 v[96:111], v[148:151], v[48:51], v[96:111]
    v_mfma_f32_32x32x16_bf16 v[96:111], v[156:159], v[56:59], v[96:111]
    s_nop 8
    ds_write_b128 v9, v[80:83] offset:8192
    ds_write_b128 v10, v[84:87] offset:8192
    ds_write_b128 v11, v[88:91] offset:8192
    ds_write_b128 v12, v[92:95] offset:8192
    v_mfma_f32_32x32x16_bf16 v[112:127], v[132:135], v[36:39], v[112:127]
    v_mfma_f32_32x32x16_bf16 v[112:127], v[140:143], v[44:47], v[112:127]
    v_mfma_f32_32x32x16_bf16 v[112:127], v[148:151], v[52:55], v[112:127]
    v_mfma_f32_32x32x16_bf16 v[112:127], v[156:159], v[60:63], v[112:127]
    s_nop 8
    ds_write_b128 v13, v[96:99] offset:0
    ds_write_b128 v14, v[100:103] offset:0
    ds_write_b128 v15, v[104:107] offset:0
    ds_write_b128 v16, v[108:111] offset:0
    s_nop 8
    s_waitcnt lgkmcnt(8)
    ds_write_b128 v13, v[112:115] offset:8192
    ds_write_b128 v14, v[116:119] offset:8192
    ds_write_b128 v15, v[120:123] offset:8192
    ds_write_b128 v16, v[124:127] offset:8192
    s_waitcnt lgkmcnt(0)
    s_barrier
L_END:
    s_endpgm
L_MAIN:
    s_lshr_b32 s6, s3, 2
    s_lshl_b32 s6, s6, 13
    s_add_u32 s6, s6, 49152
    v_and_b32 v21, 31, v0
    v_lshlrev_b32 v21, 7, v21
    v_lshrrev_b32 v22, 5, v0
    v_bfe_u32 v24, v0, 1, 3
    v_xor_b32 v24, v24, v22
    v_lshl_add_u32 v21, v24, 4, v21
    v_xor_b32 v23, 0, v21
    v_add_u32 v8, s6, v23
    v_xor_b32 v23, 32, v21
    v_add_u32 v9, s6, v23
    v_xor_b32 v23, 64, v21
    v_add_u32 v10, s6, v23
    v_xor_b32 v23, 96, v21
    v_add_u32 v11, s6, v23
    v_bfe_u32 v23, v0, 2, 2
    v_lshl_add_u32 v24, v22, 3, v23
    v_and_b32 v23, 3, v0
    v_bfe_u32 v25, v0, 4, 1
    v_mul_u32_u24 v21, 0xe0, v24
    v_lshl_add_u32 v21, v23, 3, v21
    s_and_b32 s7, s3, 3
    s_lshl_b32 s6, s7, 6
    s_add_u32 s6, s6, 65536
    s_movk_i32 s8, 14240
    s_cmp_lt_u32 s7, 2
    s_cselect_b32 s9, 14464, s8
    v_mul_u32_u24 v22, s9, v25
    v_add3_u32 v12, v21, v22, s6
    s_cmp_eq_u32 s7, 3
    s_cbranch_scc1 L_W1_Q
    s_cmp_lt_u32 s7, 1
    s_cselect_b32 s9, 14464, s8
    v_mul_u32_u24 v22, s9, v25
    v_add3_u32 v21, v21, v22, s6
    v_add_u32 v13, 32, v21
    v_add_u32 v14, 928, v21
    v_add_u32 v15, 3616, v21
    v_add_u32 v16, 4512, v21
    v_add_u32 v17, 7200, v21
    v_add_u32 v18, 8096, v21
    v_add_u32 v19, 10784, v21
    v_add_u32 v20, 11680, v21
    s_branch L_W1_E
L_W1_Q:
    v_lshlrev_b32 v21, 6, v24
    v_lshl_add_u32 v21, v23, 3, v21
    v_lshl_add_u32 v21, v25, 5, v21
    v_add_u32 v13, 94208, v21
    v_add_u32 v14, 94464, v21
    v_add_u32 v15, 95232, v21
    v_add_u32 v16, 95488, v21
    v_add_u32 v17, 96256, v21
    v_add_u32 v18, 96512, v21
    v_add_u32 v19, 97280, v21
    v_add_u32 v20, 97536, v21
L_W1_E:
    v_mov_b32 v144, 0
    v_mov_b32 v145, 0
    v_mov_b32 v146, 0
    v_mov_b32 v147, 0
    v_mov_b32 v148, 0
    v_mov_b32 v149, 0
    v_mov_b32 v150, 0
    v_mov_b32 v151, 0
    v_mov_b32 v152, 0
    v_mov_b32 v153, 0
    v_mov_b32 v154, 0
    v_mov_b32 v155, 0
    v_mov_b32 v156, 0
    v_mov_b32 v157, 0
    v_mov_b32 v158, 0
    v_mov_b32 v159, 0
    v_mov_b32 v136, 0
    v_mov_b32 v137, 0
    v_mov_b32 v138, 0
    v_mov_b32 v139, 0
    v_mov_b32 v140, 0
    v_mov_b32 v141, 0
    v_mov_b32 v142, 0
    v_mov_b32 v143, 0
    v_mov_b32 v2, v1
    v_lshrrev_b32 v21, 5, v0
    v_and_b32 v22, 15, v0
    v_lshlrev_b32 v23, 8, v21
    v_lshl_add_u32 v23, v22, 4, v23
    v_add_u32 v3, 1024, v23
    v_and_b32 v21, 27, v0
    v_cmp_eq_u32 vcc, 16, v21
    v_mov_b32 v21, 0x3f803f80
    s_mov_b32 s76, 0x0000ffff
    s_mov_b32 s77, 0x0000ffff
    v_cndmask_b32 v27, 0, v21, vcc
    v_and_b32 v21, 31, v0
    s_lshr_b32 s6, s3, 2
    s_lshl_b32 s6, s6, 8
    s_add_u32 s6, s6, 148480
    v_lshl_add_u32 v4, v21, 2, s6
    s_and_b32 s6, s3, 3
    s_lshl_b32 s6, s6, 1
    s_lshr_b32 s7, s3, 2
    s_add_u32 s6, s6, s7
    s_lshl_b32 s6, s6, 10
    s_add_u32 s6, s6, 155648
    v_add_u32 v5, s6, v1
    v_mov_b32 v6, 147520
    s_lshr_b32 s6, s3, 2
    s_lshl_b32 s6, s6, 1
    s_lshl_b32 s7, s4, 2
    s_add_u32 s6, s6, s7
    s_mul_i32 s6, s6, 144
    s_mul_i32 s7, s5, 7
    s_add_u32 s6, s6, s7
    s_and_b32 s8, s3, 3
    s_lshl_b32 s7, s8, 1
    s_add_u32 s6, s6, s7
    s_lshl_b32 s6, s6, 10
    s_add_u32 s78, s6, 2129920
    s_add_u32 s79, s78, 147456
    s_and_b32 s6, s3, 3
    s_lshl_b32 s7, s4, 2
    s_add_u32 s6, s6, s7
    s_mul_i32 s6, s6, 144
    s_lshl_b32 s7, s5, 1
    s_add_u32 s6, s6, s7
    s_lshr_b32 s7, s3, 2
    s_add_u32 s6, s6, s7
    s_lshl_b32 s6, s6, 10
    s_add_u32 s86, s6, 2097152
    s_and_b32 s6, s3, 3
    s_lshl_b32 s6, s6, 7
    s_add_u32 s6, s6, 148480
    v_lshl_add_u32 v7, v21, 2, s6
    s_waitcnt lgkmcnt(0)
    s_mov_b32 s56, s40
    s_mov_b32 s57, s41
    s_mov_b32 s58, 0x10000000
    s_mov_b32 s59, 0x20000
    s_mov_b32 s44, s36
    s_mov_b32 s45, s37
    s_mov_b32 s46, 0x200000
    s_mov_b32 s47, 0x20000
    s_mov_b32 s48, s16
    s_mov_b32 s49, s17
    s_mov_b32 s50, 0x200000
    s_mov_b32 s51, 0x20000
    s_mov_b32 s60, s34
    s_mov_b32 s61, s35
    s_mov_b32 s62, 0x400
    s_mov_b32 s63, 0x20000
    s_lshl_b32 s6, s4, 4
    s_add_u32 s6, s6, s5
    s_lshl_b32 s6, s6, 3
    s_add_u32 s6, s6, s3
    s_lshl_b32 s6, s6, 10
    s_lshl_b32 s7, s3, 2
    s_add_u32 s7, s7, 147456
    v_mov_b32 v26, s7
    s_barrier
    ds_read_b128 v[32:35], v8
    ds_read_b64_tr_b16 v[40:41], v12 offset:0
    ds_read_b64_tr_b16 v[42:43], v12 offset:896
    ds_read_b128 v[36:39], v8 offset:4096
    ds_read_b64_tr_b16 v[44:45], v13
    ds_read_b64_tr_b16 v[46:47], v14
    s_waitcnt lgkmcnt(3)
    v_mfma_f32_32x32x16_bf16 v[64:79], v[40:43], v[32:35], 0
    ds_read_b128 v[48:51], v9
    ds_read_b64_tr_b16 v[56:57], v12 offset:3584
    s_waitcnt lgkmcnt(4)
    v_mfma_f32_32x32x16_bf16 v[80:95], v[40:43], v[36:39], 0
    ds_read_b64_tr_b16 v[58:59], v12 offset:4480
    ds_read_b128 v[52:55], v9 offset:4096
    s_waitcnt lgkmcnt(4)
    v_mfma_f32_32x32x16_bf16 v[96:111], v[44:47], v[32:35], 0
    ds_read_b64_tr_b16 v[60:61], v15
    ds_read_b64_tr_b16 v[62:63], v16
    v_mfma_f32_32x32x16_bf16 v[112:127], v[44:47], v[36:39], 0
    v_add_u32 v8, 49152, v8
    v_add_u32 v13, 49152, v13
    v_add_u32 v14, 49152, v14
    s_waitcnt lgkmcnt(3)
    v_mfma_f32_32x32x16_bf16 v[64:79], v[56:59], v[48:51], v[64:79]
    ds_read_b128 v[32:35], v10
    ds_read_b64_tr_b16 v[40:41], v12 offset:7168
    s_waitcnt lgkmcnt(4)
    v_mfma_f32_32x32x16_bf16 v[80:95], v[56:59], v[52:55], v[80:95]
    ds_read_b64_tr_b16 v[42:43], v12 offset:8064
    ds_read_b128 v[36:39], v10 offset:4096
    s_waitcnt lgkmcnt(4)
    v_mfma_f32_32x32x16_bf16 v[96:111], v[60:63], v[48:51], v[96:111]
    ds_read_b64_tr_b16 v[44:45], v17
    ds_read_b64_tr_b16 v[46:47], v18
    v_mfma_f32_32x32x16_bf16 v[112:127], v[60:63], v[52:55], v[112:127]
    v_add_u32 v9, 49152, v9
    v_add_u32 v15, 49152, v15
    v_add_u32 v16, 49152, v16
    s_waitcnt lgkmcnt(3)
    v_mfma_f32_32x32x16_bf16 v[64:79], v[40:43], v[32:35], v[64:79]
    ds_read_b128 v[48:51], v11
    ds_read_b64_tr_b16 v[56:57], v12 offset:10752
    s_waitcnt lgkmcnt(4)
    v_mfma_f32_32x32x16_bf16 v[80:95], v[40:43], v[36:39], v[80:95]
    ds_read_b64_tr_b16 v[58:59], v12 offset:11648
    ds_read_b128 v[52:55], v11 offset:4096
    s_waitcnt lgkmcnt(4)
    v_mfma_f32_32x32x16_bf16 v[96:111], v[44:47], v[32:35], v[96:111]
    ds_read_b64_tr_b16 v[60:61], v19
    ds_read_b64_tr_b16 v[62:63], v20
    v_mfma_f32_32x32x16_bf16 v[112:127], v[44:47], v[36:39], v[112:127]
    v_add_u32 v10, 49152, v10
    v_add_u32 v17, 49152, v17
    v_add_u32 v18, 49152, v18
    v_add_u32 v11, 49152, v11
    v_add_u32 v19, 49152, v19
    v_add_u32 v20, 49152, v20
    v_add_u32 v12, 49152, v12
    s_waitcnt lgkmcnt(3)
    v_mfma_f32_32x32x16_bf16 v[64:79], v[56:59], v[48:51], v[64:79]
    s_waitcnt lgkmcnt(0)
    s_barrier
    ds_read_b128 v[32:35], v8
    ds_read_b64_tr_b16 v[40:41], v12 offset:0
    ds_read_b64_tr_b16 v[42:43], v12 offset:896
    v_mfma_f32_32x32x16_bf16 v[80:95], v[56:59], v[52:55], v[80:95]
    ds_read_b128 v[36:39], v8 offset:4096
    ds_read_b64_tr_b16 v[44:45], v13
    ds_read_b64_tr_b16 v[46:47], v14
    v_mfma_f32_32x32x16_bf16 v[96:111], v[60:63], v[48:51], v[96:111]
    v_mfma_f32_32x32x16_bf16 v[112:127], v[60:63], v[52:55], v[112:127]
    s_waitcnt lgkmcnt(3)
    v_mfma_f32_32x32x16_bf16 v[64:79], v[40:43], v[32:35], v[64:79]
    ds_read_b128 v[48:51], v9
    ds_read_b64_tr_b16 v[56:57], v12 offset:3584
    s_waitcnt lgkmcnt(4)
    v_mfma_f32_32x32x16_bf16 v[80:95], v[40:43], v[36:39], v[80:95]
    ds_read_b64_tr_b16 v[58:59], v12 offset:4480
    ds_read_b128 v[52:55], v9 offset:4096
    s_waitcnt lgkmcnt(4)
    v_mfma_f32_32x32x16_bf16 v[96:111], v[44:47], v[32:35], v[96:111]
    ds_read_b64_tr_b16 v[60:61], v15
    ds_read_b64_tr_b16 v[62:63], v16
    v_mfma_f32_32x32x16_bf16 v[112:127], v[44:47], v[36:39], v[112:127]
    v_subrev_u32 v8, 98304, v8
    v_subrev_u32 v13, 98304, v13
    v_subrev_u32 v14, 98304, v14
    s_waitcnt lgkmcnt(3)
    v_mfma_f32_32x32x16_bf16 v[64:79], v[56:59], v[48:51], v[64:79]
    ds_read_b128 v[32:35], v10
    ds_read_b64_tr_b16 v[40:41], v12 offset:7168
    s_waitcnt lgkmcnt(4)
    v_mfma_f32_32x32x16_bf16 v[80:95], v[56:59], v[52:55], v[80:95]
    ds_read_b64_tr_b16 v[42:43], v12 offset:8064
    ds_read_b128 v[36:39], v10 offset:4096
    s_waitcnt lgkmcnt(4)
    v_mfma_f32_32x32x16_bf16 v[96:111], v[60:63], v[48:51], v[96:111]
    ds_read_b64_tr_b16 v[44:45], v17
    ds_read_b64_tr_b16 v[46:47], v18
    v_mfma_f32_32x32x16_bf16 v[112:127], v[60:63], v[52:55], v[112:127]
    v_subrev_u32 v9, 98304, v9
    v_subrev_u32 v15, 98304, v15
    v_subrev_u32 v16, 98304, v16
    s_waitcnt lgkmcnt(3)
    v_mfma_f32_32x32x16_bf16 v[64:79], v[40:43], v[32:35], v[64:79]
    ds_read_b128 v[48:51], v11
    ds_read_b64_tr_b16 v[56:57], v12 offset:10752
    s_waitcnt lgkmcnt(4)
    v_mfma_f32_32x32x16_bf16 v[80:95], v[40:43], v[36:39], v[80:95]
    ds_read_b64_tr_b16 v[58:59], v12 offset:11648
    ds_read_b128 v[52:55], v11 offset:4096
    s_waitcnt lgkmcnt(4)
    v_mfma_f32_32x32x16_bf16 v[96:111], v[44:47], v[32:35], v[96:111]
    ds_read_b64_tr_b16 v[60:61], v19
    ds_read_b64_tr_b16 v[62:63], v20
    v_mfma_f32_32x32x16_bf16 v[112:127], v[44:47], v[36:39], v[112:127]
    v_subrev_u32 v10, 98304, v10
    v_subrev_u32 v17, 98304, v17
    v_subrev_u32 v18, 98304, v18
    v_subrev_u32 v11, 98304, v11
    v_subrev_u32 v19, 98304, v19
    v_subrev_u32 v20, 98304, v20
    v_subrev_u32 v12, 98304, v12
    s_waitcnt lgkmcnt(3)
    v_mfma_f32_32x32x16_bf16 v[64:79], v[56:59], v[48:51], v[64:79]
    s_waitcnt lgkmcnt(0)
    s_barrier
    ds_read_b128 v[32:35], v8
    ds_read_b64_tr_b16 v[40:41], v12 offset:0
    ds_read_b64_tr_b16 v[42:43], v12 offset:896
    v_mfma_f32_32x32x16_bf16 v[80:95], v[56:59], v[52:55], v[80:95]
    ds_read_b128 v[36:39], v8 offset:4096
    ds_read_b64_tr_b16 v[44:45], v13
    ds_read_b64_tr_b16 v[46:47], v14
    v_mfma_f32_32x32x16_bf16 v[96:111], v[60:63], v[48:51], v[96:111]
    v_mfma_f32_32x32x16_bf16 v[112:127], v[60:63], v[52:55], v[112:127]
    s_waitcnt vmcnt(0)
    v_mov_b32 v21, 0
    v_dot2_f32_bf16 v21, v128, v132, v21
    v_dot2_f32_bf16 v21, v129, v133, v21
    v_dot2_f32_bf16 v21, v130, v134, v21
    v_dot2_f32_bf16 v21, v131, v135, v21
    v_mov_b32 v128, 0
    v_mov_b32 v129, 0
    v_mov_b32 v130, 0
    v_mov_b32 v131, 0
    v_mov_b32 v132, 0
    v_mov_b32 v133, 0
    v_mov_b32 v134, 0
    v_mov_b32 v135, 0
    v_mov_b32 v22, v21
    s_nop 1
    v_add_f32_dpp v22, v22, v22 row_shr:1 row_mask:0xf bank_mask:0xf bound_ctrl:0
    s_nop 1
    v_add_f32_dpp v22, v22, v22 row_shr:2 row_mask:0xf bank_mask:0xf bound_ctrl:0
    s_nop 1
    v_add_f32_dpp v22, v22, v22 row_shr:4 row_mask:0xf bank_mask:0xf bound_ctrl:0
    s_nop 1
    v_add_f32_dpp v22, v22, v22 row_shr:8 row_mask:0xf bank_mask:0xf bound_ctrl:0
    s_nop 1
    v_add_f32_dpp v22, v22, v22 row_bcast:15 row_mask:0xa bank_mask:0xf
    s_nop 1
    v_add_f32_dpp v22, v22, v22 row_bcast:31 row_mask:0xc bank_mask:0xf
    v_mul_f32 v22, 0xbfb8aa3b, v22
    v_exp_f32 v22, v22
    s_nop 0
    v_add_f32 v22, 1.0, v22
    v_rcp_f32 v22, v22
    s_mov_b32 exec_lo, 0
    s_mov_b32 exec_hi, 0x80000000
    ds_write_b32 v26, v22
    s_mov_b64 exec, -1
    s_waitcnt lgkmcnt(3)
    v_mfma_f32_32x32x16_bf16 v[64:79], v[40:43], v[32:35], v[64:79]
    ds_read_b128 v[48:51], v9
    ds_read_b64_tr_b16 v[56:57], v12 offset:3584
    s_waitcnt lgkmcnt(4)
    v_mfma_f32_32x32x16_bf16 v[80:95], v[40:43], v[36:39], v[80:95]
    ds_read_b64_tr_b16 v[58:59], v12 offset:4480
    ds_read_b128 v[52:55], v9 offset:4096
    s_waitcnt lgkmcnt(4)
    v_mfma_f32_32x32x16_bf16 v[96:111], v[44:47], v[32:35], v[96:111]
    ds_read_b64_tr_b16 v[60:61], v15
    ds_read_b64_tr_b16 v[62:63], v16
    v_mfma_f32_32x32x16_bf16 v[112:127], v[44:47], v[36:39], v[112:127]
    v_add_u32 v8, 49152, v8
    v_add_u32 v13, 49152, v13
    v_add_u32 v14, 49152, v14
    s_waitcnt lgkmcnt(3)
    v_mfma_f32_32x32x16_bf16 v[64:79], v[56:59], v[48:51], v[64:79]
    ds_read_b128 v[32:35], v10
    ds_read_b64_tr_b16 v[40:41], v12 offset:7168
    s_waitcnt lgkmcnt(4)
    v_mfma_f32_32x32x16_bf16 v[80:95], v[56:59], v[52:55], v[80:95]
    ds_read_b64_tr_b16 v[42:43], v12 offset:8064
    ds_read_b128 v[36:39], v10 offset:4096
    s_waitcnt lgkmcnt(4)
    v_mfma_f32_32x32x16_bf16 v[96:111], v[60:63], v[48:51], v[96:111]
    ds_read_b64_tr_b16 v[44:45], v17
    ds_read_b64_tr_b16 v[46:47], v18
    v_mfma_f32_32x32x16_bf16 v[112:127], v[60:63], v[52:55], v[112:127]
    v_add_u32 v9, 49152, v9
    v_add_u32 v15, 49152, v15
    v_add_u32 v16, 49152, v16
    s_waitcnt lgkmcnt(3)
    v_mfma_f32_32x32x16_bf16 v[64:79], v[40:43], v[32:35], v[64:79]
    ds_read_b128 v[48:51], v11
    ds_read_b64_tr_b16 v[56:57], v12 offset:10752
    s_waitcnt lgkmcnt(4)
    v_mfma_f32_32x32x16_bf16 v[80:95], v[40:43], v[36:39], v[80:95]
    ds_read_b64_tr_b16 v[58:59], v12 offset:11648
    ds_read_b128 v[52:55], v11 offset:4096
    s_waitcnt lgkmcnt(4)
    v_mfma_f32_32x32x16_bf16 v[96:111], v[44:47], v[32:35], v[96:111]
    ds_read_b64_tr_b16 v[60:61], v19
    ds_read_b64_tr_b16 v[62:63], v20
    v_mfma_f32_32x32x16_bf16 v[112:127], v[44:47], v[36:39], v[112:127]
    v_add_u32 v10, 49152, v10
    v_add_u32 v17, 49152, v17
    v_add_u32 v18, 49152, v18
    v_add_u32 v11, 49152, v11
    v_add_u32 v19, 49152, v19
    v_add_u32 v20, 49152, v20
    v_add_u32 v12, 49152, v12
    s_waitcnt lgkmcnt(3)
    v_mfma_f32_32x32x16_bf16 v[64:79], v[56:59], v[48:51], v[64:79]
    s_waitcnt lgkmcnt(0)
    s_barrier
    ds_read_b128 v[32:35], v8
    ds_read_b64_tr_b16 v[40:41], v12 offset:0
    ds_read_b64_tr_b16 v[42:43], v12 offset:896
    v_mfma_f32_32x32x16_bf16 v[80:95], v[56:59], v[52:55], v[80:95]
    ds_read_b128 v[36:39], v8 offset:4096
    ds_read_b64_tr_b16 v[44:45], v13
    ds_read_b64_tr_b16 v[46:47], v14
    v_mfma_f32_32x32x16_bf16 v[96:111], v[60:63], v[48:51], v[96:111]
    v_mfma_f32_32x32x16_bf16 v[112:127], v[60:63], v[52:55], v[112:127]
    s_waitcnt lgkmcnt(3)
    v_mfma_f32_32x32x16_bf16 v[64:79], v[40:43], v[32:35], v[64:79]
    ds_read_b128 v[48:51], v9
    ds_read_b64_tr_b16 v[56:57], v12 offset:3584
    s_waitcnt lgkmcnt(4)
    v_mfma_f32_32x32x16_bf16 v[80:95], v[40:43], v[36:39], v[80:95]
    ds_read_b64_tr_b16 v[58:59], v12 offset:4480
    ds_read_b128 v[52:55], v9 offset:4096
    s_waitcnt lgkmcnt(4)
    v_mfma_f32_32x32x16_bf16 v[96:111], v[44:47], v[32:35], v[96:111]
    ds_read_b64_tr_b16 v[60:61], v15
    ds_read_b64_tr_b16 v[62:63], v16
    v_mfma_f32_32x32x16_bf16 v[112:127], v[44:47], v[36:39], v[112:127]
    v_add_u32 v8, 49152, v8
    v_add_u32 v13, 49152, v13
    v_add_u32 v14, 49152, v14
    s_waitcnt lgkmcnt(3)
    v_mfma_f32_32x32x16_bf16 v[64:79], v[56:59], v[48:51], v[64:79]
    ds_read_b128 v[32:35], v10
    ds_read_b64_tr_b16 v[40:41], v12 offset:7168
    s_waitcnt lgkmcnt(4)
    v_mfma_f32_32x32x16_bf16 v[80:95], v[56:59], v[52:55], v[80:95]
    ds_read_b64_tr_b16 v[42:43], v12 offset:8064
    ds_read_b128 v[36:39], v10 offset:4096
    s_waitcnt lgkmcnt(4)
    v_mfma_f32_32x32x16_bf16 v[96:111], v[60:63], v[48:51], v[96:111]
    ds_read_b64_tr_b16 v[44:45], v17
    ds_read_b64_tr_b16 v[46:47], v18
    v_mfma_f32_32x32x16_bf16 v[112:127], v[60:63], v[52:55], v[112:127]
    v_add_u32 v9, 49152, v9
    v_add_u32 v15, 49152, v15
    v_add_u32 v16, 49152, v16
    s_waitcnt lgkmcnt(3)
    v_mfma_f32_32x32x16_bf16 v[64:79], v[40:43], v[32:35], v[64:79]
    ds_read_b128 v[48:51], v11
    ds_read_b64_tr_b16 v[56:57], v12 offset:10752
    s_waitcnt lgkmcnt(4)
    v_mfma_f32_32x32x16_bf16 v[80:95], v[40:43], v[36:39], v[80:95]
    ds_read_b64_tr_b16 v[58:59], v12 offset:11648
    ds_read_b128 v[52:55], v11 offset:4096
    s_waitcnt lgkmcnt(4)
    v_mfma_f32_32x32x16_bf16 v[96:111], v[44:47], v[32:35], v[96:111]
    ds_read_b64_tr_b16 v[60:61], v19
    ds_read_b64_tr_b16 v[62:63], v20
    v_mfma_f32_32x32x16_bf16 v[112:127], v[44:47], v[36:39], v[112:127]
    v_add_u32 v10, 49152, v10
    v_add_u32 v17, 49152, v17
    v_add_u32 v18, 49152, v18
    v_add_u32 v11, 49152, v11
    v_add_u32 v19, 49152, v19
    v_add_u32 v20, 49152, v20
    v_add_u32 v12, 49152, v12
    s_waitcnt lgkmcnt(3)
    v_mfma_f32_32x32x16_bf16 v[64:79], v[56:59], v[48:51], v[64:79]
    s_waitcnt lgkmcnt(0)
    s_barrier
    ds_read_b128 v[32:35], v8
    ds_read_b64_tr_b16 v[40:41], v12 offset:0
    ds_read_b64_tr_b16 v[42:43], v12 offset:896
    v_mfma_f32_32x32x16_bf16 v[80:95], v[56:59], v[52:55], v[80:95]
    ds_read_b128 v[36:39], v8 offset:4096
    ds_read_b64_tr_b16 v[44:45], v13
    ds_read_b64_tr_b16 v[46:47], v14
    v_mfma_f32_32x32x16_bf16 v[96:111], v[60:63], v[48:51], v[96:111]
    v_mfma_f32_32x32x16_bf16 v[112:127], v[60:63], v[52:55], v[112:127]
    s_waitcnt lgkmcnt(3)
    v_mfma_f32_32x32x16_bf16 v[64:79], v[40:43], v[32:35], v[64:79]
    ds_read_b128 v[48:51], v9
    ds_read_b64_tr_b16 v[56:57], v12 offset:3584
    s_waitcnt lgkmcnt(4)
    v_mfma_f32_32x32x16_bf16 v[80:95], v[40:43], v[36:39], v[80:95]
    ds_read_b64_tr_b16 v[58:59], v12 offset:4480
    ds_read_b128 v[52:55], v9 offset:4096
    s_waitcnt lgkmcnt(4)
    v_mfma_f32_32x32x16_bf16 v[96:111], v[44:47], v[32:35], v[96:111]
    ds_read_b64_tr_b16 v[60:61], v15
    ds_read_b64_tr_b16 v[62:63], v16
    v_mfma_f32_32x32x16_bf16 v[112:127], v[44:47], v[36:39], v[112:127]
    v_subrev_u32 v8, 98304, v8
    v_subrev_u32 v13, 98304, v13
    v_subrev_u32 v14, 98304, v14
    s_waitcnt lgkmcnt(3)
    v_mfma_f32_32x32x16_bf16 v[64:79], v[56:59], v[48:51], v[64:79]
    ds_read_b128 v[32:35], v10
    ds_read_b64_tr_b16 v[40:41], v12 offset:7168
    s_waitcnt lgkmcnt(4)
    v_mfma_f32_32x32x16_bf16 v[80:95], v[56:59], v[52:55], v[80:95]
    ds_read_b64_tr_b16 v[42:43], v12 offset:8064
    ds_read_b128 v[36:39], v10 offset:4096
    s_waitcnt lgkmcnt(4)
    v_mfma_f32_32x32x16_bf16 v[96:111], v[60:63], v[48:51], v[96:111]
    ds_read_b64_tr_b16 v[44:45], v17
    ds_read_b64_tr_b16 v[46:47], v18
    v_mfma_f32_32x32x16_bf16 v[112:127], v[60:63], v[52:55], v[112:127]
    v_subrev_u32 v9, 98304, v9
    v_subrev_u32 v15, 98304, v15
    v_subrev_u32 v16, 98304, v16
    s_waitcnt lgkmcnt(3)
    v_mfma_f32_32x32x16_bf16 v[64:79], v[40:43], v[32:35], v[64:79]
    ds_read_b128 v[48:51], v11
    ds_read_b64_tr_b16 v[56:57], v12 offset:10752
    s_waitcnt lgkmcnt(4)
    v_mfma_f32_32x32x16_bf16 v[80:95], v[40:43], v[36:39], v[80:95]
    ds_read_b64_tr_b16 v[58:59], v12 offset:11648
    ds_read_b128 v[52:55], v11 offset:4096
    s_waitcnt lgkmcnt(4)
    v_mfma_f32_32x32x16_bf16 v[96:111], v[44:47], v[32:35], v[96:111]
    ds_read_b64_tr_b16 v[60:61], v19
    ds_read_b64_tr_b16 v[62:63], v20
    v_mfma_f32_32x32x16_bf16 v[112:127], v[44:47], v[36:39], v[112:127]
    v_subrev_u32 v10, 98304, v10
    v_subrev_u32 v17, 98304, v17
    v_subrev_u32 v18, 98304, v18
    v_subrev_u32 v11, 98304, v11
    v_subrev_u32 v19, 98304, v19
    v_subrev_u32 v20, 98304, v20
    v_subrev_u32 v12, 98304, v12
    s_waitcnt lgkmcnt(3)
    v_mfma_f32_32x32x16_bf16 v[64:79], v[56:59], v[48:51], v[64:79]
    s_waitcnt lgkmcnt(0)
    s_barrier
    ds_read_b128 v[32:35], v8
    ds_read_b64_tr_b16 v[40:41], v12 offset:0
    ds_read_b64_tr_b16 v[42:43], v12 offset:896
    v_mfma_f32_32x32x16_bf16 v[80:95], v[56:59], v[52:55], v[80:95]
    ds_read_b128 v[36:39], v8 offset:4096
    ds_read_b64_tr_b16 v[44:45], v13
    ds_read_b64_tr_b16 v[46:47], v14
    v_mfma_f32_32x32x16_bf16 v[96:111], v[60:63], v[48:51], v[96:111]
    v_mfma_f32_32x32x16_bf16 v[112:127], v[60:63], v[52:55], v[112:127]
    s_waitcnt lgkmcnt(3)
    v_mfma_f32_32x32x16_bf16 v[64:79], v[40:43], v[32:35], v[64:79]
    ds_read_b128 v[48:51], v9
    ds_read_b64_tr_b16 v[56:57], v12 offset:3584
    s_waitcnt lgkmcnt(4)
    v_mfma_f32_32x32x16_bf16 v[80:95], v[40:43], v[36:39], v[80:95]
    ds_read_b64_tr_b16 v[58:59], v12 offset:4480
    ds_read_b128 v[52:55], v9 offset:4096
    s_waitcnt lgkmcnt(4)
    v_mfma_f32_32x32x16_bf16 v[96:111], v[44:47], v[32:35], v[96:111]
    ds_read_b64_tr_b16 v[60:61], v15
    ds_read_b64_tr_b16 v[62:63], v16
    v_mfma_f32_32x32x16_bf16 v[112:127], v[44:47], v[36:39], v[112:127]
    v_add_u32 v8, 49152, v8
    v_add_u32 v13, 49152, v13
    v_add_u32 v14, 49152, v14
    s_waitcnt lgkmcnt(3)
    v_mfma_f32_32x32x16_bf16 v[64:79], v[56:59], v[48:51], v[64:79]
    ds_read_b128 v[32:35], v10
    ds_read_b64_tr_b16 v[40:41], v12 offset:7168
    s_waitcnt lgkmcnt(4)
    v_mfma_f32_32x32x16_bf16 v[80:95], v[56:59], v[52:55], v[80:95]
    ds_read_b64_tr_b16 v[42:43], v12 offset:8064
    ds_read_b128 v[36:39], v10 offset:4096
    s_waitcnt lgkmcnt(4)
    v_mfma_f32_32x32x16_bf16 v[96:111], v[60:63], v[48:51], v[96:111]
    ds_read_b64_tr_b16 v[44:45], v17
    ds_read_b64_tr_b16 v[46:47], v18
    v_mfma_f32_32x32x16_bf16 v[112:127], v[60:63], v[52:55], v[112:127]
    v_add_u32 v9, 49152, v9
    v_add_u32 v15, 49152, v15
    v_add_u32 v16, 49152, v16
    s_waitcnt lgkmcnt(3)
    v_mfma_f32_32x32x16_bf16 v[64:79], v[40:43], v[32:35], v[64:79]
    ds_read_b128 v[48:51], v11
    ds_read_b64_tr_b16 v[56:57], v12 offset:10752
    s_waitcnt lgkmcnt(4)
    v_mfma_f32_32x32x16_bf16 v[80:95], v[40:43], v[36:39], v[80:95]
    ds_read_b64_tr_b16 v[58:59], v12 offset:11648
    ds_read_b128 v[52:55], v11 offset:4096
    s_waitcnt lgkmcnt(4)
    v_mfma_f32_32x32x16_bf16 v[96:111], v[44:47], v[32:35], v[96:111]
    ds_read_b64_tr_b16 v[60:61], v19
    ds_read_b64_tr_b16 v[62:63], v20
    v_mfma_f32_32x32x16_bf16 v[112:127], v[44:47], v[36:39], v[112:127]
    v_add_u32 v10, 49152, v10
    v_add_u32 v17, 49152, v17
    v_add_u32 v18, 49152, v18
    v_add_u32 v11, 49152, v11
    v_add_u32 v19, 49152, v19
    v_add_u32 v20, 49152, v20
    v_add_u32 v12, 49152, v12
    s_waitcnt lgkmcnt(3)
    v_mfma_f32_32x32x16_bf16 v[64:79], v[56:59], v[48:51], v[64:79]
    s_waitcnt lgkmcnt(0)
    s_barrier
    ds_read_b128 v[32:35], v8
    ds_read_b64_tr_b16 v[40:41], v12 offset:0
    ds_read_b64_tr_b16 v[42:43], v12 offset:896
    v_mfma_f32_32x32x16_bf16 v[80:95], v[56:59], v[52:55], v[80:95]
    ds_read_b128 v[36:39], v8 offset:4096
    ds_read_b64_tr_b16 v[44:45], v13
    ds_read_b64_tr_b16 v[46:47], v14
    v_mfma_f32_32x32x16_bf16 v[96:111], v[60:63], v[48:51], v[96:111]
    v_mfma_f32_32x32x16_bf16 v[112:127], v[60:63], v[52:55], v[112:127]
    s_waitcnt lgkmcnt(3)
    v_mfma_f32_32x32x16_bf16 v[64:79], v[40:43], v[32:35], v[64:79]
    ds_read_b128 v[48:51], v9
    ds_read_b64_tr_b16 v[56:57], v12 offset:3584
    s_waitcnt lgkmcnt(4)
    v_mfma_f32_32x32x16_bf16 v[80:95], v[40:43], v[36:39], v[80:95]
    ds_read_b64_tr_b16 v[58:59], v12 offset:4480
    ds_read_b128 v[52:55], v9 offset:4096
    s_waitcnt lgkmcnt(4)
    v_mfma_f32_32x32x16_bf16 v[96:111], v[44:47], v[32:35], v[96:111]
    ds_read_b64_tr_b16 v[60:61], v15
    ds_read_b64_tr_b16 v[62:63], v16
    v_mfma_f32_32x32x16_bf16 v[112:127], v[44:47], v[36:39], v[112:127]
    v_add_u32 v8, 49152, v8
    v_add_u32 v13, 49152, v13
    v_add_u32 v14, 49152, v14
    s_waitcnt lgkmcnt(3)
    v_mfma_f32_32x32x16_bf16 v[64:79], v[56:59], v[48:51], v[64:79]
    ds_read_b128 v[32:35], v10
    ds_read_b64_tr_b16 v[40:41], v12 offset:7168
    s_waitcnt lgkmcnt(4)
    v_mfma_f32_32x32x16_bf16 v[80:95], v[56:59], v[52:55], v[80:95]
    ds_read_b64_tr_b16 v[42:43], v12 offset:8064
    ds_read_b128 v[36:39], v10 offset:4096
    s_waitcnt lgkmcnt(4)
    v_mfma_f32_32x32x16_bf16 v[96:111], v[60:63], v[48:51], v[96:111]
    ds_read_b64_tr_b16 v[44:45], v17
    ds_read_b64_tr_b16 v[46:47], v18
    v_mfma_f32_32x32x16_bf16 v[112:127], v[60:63], v[52:55], v[112:127]
    v_add_u32 v9, 49152, v9
    v_add_u32 v15, 49152, v15
    v_add_u32 v16, 49152, v16
    s_waitcnt lgkmcnt(3)
    v_mfma_f32_32x32x16_bf16 v[64:79], v[40:43], v[32:35], v[64:79]
    ds_read_b128 v[48:51], v11
    ds_read_b64_tr_b16 v[56:57], v12 offset:10752
    s_waitcnt lgkmcnt(4)
    v_mfma_f32_32x32x16_bf16 v[80:95], v[40:43], v[36:39], v[80:95]
    ds_read_b64_tr_b16 v[58:59], v12 offset:11648
    ds_read_b128 v[52:55], v11 offset:4096
    s_waitcnt lgkmcnt(4)
    v_mfma_f32_32x32x16_bf16 v[96:111], v[44:47], v[32:35], v[96:111]
    ds_read_b64_tr_b16 v[60:61], v19
    ds_read_b64_tr_b16 v[62:63], v20
    v_mfma_f32_32x32x16_bf16 v[112:127], v[44:47], v[36:39], v[112:127]
    v_add_u32 v10, 49152, v10
    v_add_u32 v17, 49152, v17
    v_add_u32 v18, 49152, v18
    v_add_u32 v11, 49152, v11
    v_add_u32 v19, 49152, v19
    v_add_u32 v20, 49152, v20
    v_add_u32 v12, 49152, v12
    s_waitcnt lgkmcnt(3)
    v_mfma_f32_32x32x16_bf16 v[64:79], v[56:59], v[48:51], v[64:79]
    s_waitcnt lgkmcnt(0)
    s_barrier
    ds_read_b128 v[32:35], v8
    ds_read_b64_tr_b16 v[40:41], v12 offset:0
    ds_read_b64_tr_b16 v[42:43], v12 offset:896
    v_mfma_f32_32x32x16_bf16 v[80:95], v[56:59], v[52:55], v[80:95]
    ds_read_b128 v[36:39], v8 offset:4096
    ds_read_b64_tr_b16 v[44:45], v13
    ds_read_b64_tr_b16 v[46:47], v14
    v_mfma_f32_32x32x16_bf16 v[96:111], v[60:63], v[48:51], v[96:111]
    v_mfma_f32_32x32x16_bf16 v[112:127], v[60:63], v[52:55], v[112:127]
    s_waitcnt lgkmcnt(3)
    v_mfma_f32_32x32x16_bf16 v[64:79], v[40:43], v[32:35], v[64:79]
    ds_read_b128 v[48:51], v9
    ds_read_b64_tr_b16 v[56:57], v12 offset:3584
    s_waitcnt lgkmcnt(4)
    v_mfma_f32_32x32x16_bf16 v[80:95], v[40:43], v[36:39], v[80:95]
    ds_read_b64_tr_b16 v[58:59], v12 offset:4480
    ds_read_b128 v[52:55], v9 offset:4096
    s_waitcnt lgkmcnt(4)
    v_mfma_f32_32x32x16_bf16 v[96:111], v[44:47], v[32:35], v[96:111]
    ds_read_b64_tr_b16 v[60:61], v15
    ds_read_b64_tr_b16 v[62:63], v16
    v_mfma_f32_32x32x16_bf16 v[112:127], v[44:47], v[36:39], v[112:127]
    s_waitcnt lgkmcnt(3)
    v_mfma_f32_32x32x16_bf16 v[64:79], v[56:59], v[48:51], v[64:79]
    ds_read_b128 v[32:35], v10
    ds_read_b64_tr_b16 v[40:41], v12 offset:7168
    s_waitcnt lgkmcnt(4)
    v_mfma_f32_32x32x16_bf16 v[80:95], v[56:59], v[52:55], v[80:95]
    ds_read_b64_tr_b16 v[42:43], v12 offset:8064
    ds_read_b128 v[36:39], v10 offset:4096
    s_waitcnt lgkmcnt(4)
    v_mfma_f32_32x32x16_bf16 v[96:111], v[60:63], v[48:51], v[96:111]
    ds_read_b64_tr_b16 v[44:45], v17
    ds_read_b64_tr_b16 v[46:47], v18
    v_mfma_f32_32x32x16_bf16 v[112:127], v[60:63], v[52:55], v[112:127]
    s_waitcnt lgkmcnt(3)
    v_mfma_f32_32x32x16_bf16 v[64:79], v[40:43], v[32:35], v[64:79]
    ds_read_b128 v[48:51], v11
    ds_read_b64_tr_b16 v[56:57], v12 offset:10752
    s_waitcnt lgkmcnt(4)
    v_mfma_f32_32x32x16_bf16 v[80:95], v[40:43], v[36:39], v[80:95]
    ds_read_b64_tr_b16 v[58:59], v12 offset:11648
    ds_read_b128 v[52:55], v11 offset:4096
    s_waitcnt lgkmcnt(4)
    v_mfma_f32_32x32x16_bf16 v[96:111], v[44:47], v[32:35], v[96:111]
    ds_read_b64_tr_b16 v[60:61], v19
    ds_read_b64_tr_b16 v[62:63], v20
    v_mfma_f32_32x32x16_bf16 v[112:127], v[44:47], v[36:39], v[112:127]
    ds_read_b32 v28, v4
    ds_read_b32 v30, v4 offset:128
    ds_read_b32 v26, v7
    s_waitcnt lgkmcnt(6)
    v_mfma_f32_32x32x16_bf16 v[64:79], v[56:59], v[48:51], v[64:79]
    s_waitcnt lgkmcnt(3)
    v_mfma_f32_32x32x16_bf16 v[80:95], v[56:59], v[52:55], v[80:95]
    v_mfma_f32_32x32x16_bf16 v[96:111], v[60:63], v[48:51], v[96:111]
    v_mfma_f32_32x32x16_bf16 v[112:127], v[60:63], v[52:55], v[112:127]
    s_bitcmp1_b32 s3, 1
    s_cselect_b64 vcc, -1, 0
    v_mov_b32 v8, -1
    v_mov_b32 v9, -1
    v_mov_b32 v10, -1
    v_mov_b32 v11, -1
    s_waitcnt lgkmcnt(0)
    buffer_store_dwordx4 v[8:11], v1, s[56:59], s86 offen sc1
    v_sub_f32 v28, 1.0, v28
    v_sub_f32 v30, 1.0, v30
    v_mov_b32 v29, v28
    v_mov_b32 v31, v30
    s_cmp_eq_u32 s8, 3
    s_cbranch_scc1 L_EPI_Q
    v_pk_mul_f32 v[96:97], v[96:97], v[104:105]
    v_pk_mul_f32 v[98:99], v[98:99], v[106:107]
    v_pk_mul_f32 v[100:101], v[100:101], v[108:109]
    v_pk_mul_f32 v[102:103], v[102:103], v[110:111]
    v_pk_mul_f32 v[96:97], v[96:97], v[28:29]
    v_pk_mul_f32 v[98:99], v[98:99], v[28:29]
    v_pk_mul_f32 v[100:101], v[100:101], v[28:29]
    v_pk_mul_f32 v[102:103], v[102:103], v[28:29]
    v_cvt_pk_bf16_f32 v104, v96, v97
    v_cvt_pk_bf16_f32 v105, v98, v99
    v_cvt_pk_bf16_f32 v106, v100, v101
    v_cvt_pk_bf16_f32 v107, v102, v103
    buffer_store_dwordx4 v[104:107], v1, s[56:59], s78 offen offset:1024 sc1
    v_pk_mul_f32 v[112:113], v[112:113], v[120:121]
    v_pk_mul_f32 v[114:115], v[114:115], v[122:123]
    v_pk_mul_f32 v[116:117], v[116:117], v[124:125]
    v_pk_mul_f32 v[118:119], v[118:119], v[126:127]
    v_pk_mul_f32 v[112:113], v[112:113], v[30:31]
    v_pk_mul_f32 v[114:115], v[114:115], v[30:31]
    v_pk_mul_f32 v[116:117], v[116:117], v[30:31]
    v_pk_mul_f32 v[118:119], v[118:119], v[30:31]
    v_cvt_pk_bf16_f32 v120, v112, v113
    v_cvt_pk_bf16_f32 v121, v114, v115
    v_cvt_pk_bf16_f32 v122, v116, v117
    v_cvt_pk_bf16_f32 v123, v118, v119
    buffer_store_dwordx4 v[120:123], v1, s[56:59], s79 offen offset:1024 sc1
    s_branch L_EPI_C
L_EPI_Q:
    v_mov_b32 v24, 0x3eb8aa3b
    v_mov_b32 v25, 0x3eb8aa3b
    s_lshr_b32 s8, s3, 2
    s_lshl_b32 s8, s8, 12
    s_add_u32 s8, s8, 155648
    v_add_u32 v21, s8, v1
    v_pk_mul_f32 v[96:97], v[96:97], v[24:25]
    v_pk_mul_f32 v[98:99], v[98:99], v[24:25]
    v_pk_mul_f32 v[100:101], v[100:101], v[24:25]
    v_pk_mul_f32 v[102:103], v[102:103], v[24:25]
    v_pk_mul_f32 v[104:105], v[104:105], v[24:25]
    v_pk_mul_f32 v[106:107], v[106:107], v[24:25]
    v_pk_mul_f32 v[108:109], v[108:109], v[24:25]
    v_pk_mul_f32 v[110:111], v[110:111], v[24:25]
    v_cvt_pk_bf16_f32 v32, v96, v97
    v_cvt_pk_bf16_f32 v33, v98, v99
    v_cvt_pk_bf16_f32 v34, v100, v101
    v_cvt_pk_bf16_f32 v35, v102, v103
    v_cvt_pk_bf16_f32 v36, v104, v105
    v_cvt_pk_bf16_f32 v37, v106, v107
    v_cvt_pk_bf16_f32 v38, v108, v109
    v_cvt_pk_bf16_f32 v39, v110, v111
    ds_write_b128 v21, v[32:35] offset:0
    ds_write_b128 v21, v[36:39] offset:1024
    v_pk_mul_f32 v[112:113], v[112:113], v[24:25]
    v_pk_mul_f32 v[114:115], v[114:115], v[24:25]
    v_pk_mul_f32 v[116:117], v[116:117], v[24:25]
    v_pk_mul_f32 v[118:119], v[118:119], v[24:25]
    v_pk_mul_f32 v[120:121], v[120:121], v[24:25]
    v_pk_mul_f32 v[122:123], v[122:123], v[24:25]
    v_pk_mul_f32 v[124:125], v[124:125], v[24:25]
    v_pk_mul_f32 v[126:127], v[126:127], v[24:25]
    v_cvt_pk_bf16_f32 v40, v112, v113
    v_cvt_pk_bf16_f32 v41, v114, v115
    v_cvt_pk_bf16_f32 v42, v116, v117
    v_cvt_pk_bf16_f32 v43, v118, v119
    v_cvt_pk_bf16_f32 v44, v120, v121
    v_cvt_pk_bf16_f32 v45, v122, v123
    v_cvt_pk_bf16_f32 v46, v124, v125
    v_cvt_pk_bf16_f32 v47, v126, v127
    ds_write_b128 v21, v[40:43] offset:2048
    ds_write_b128 v21, v[44:47] offset:3072
L_EPI_C:
    v_pk_mul_f32 v[64:65], v[64:65], v[72:73]
    v_pk_mul_f32 v[66:67], v[66:67], v[74:75]
    v_pk_mul_f32 v[68:69], v[68:69], v[76:77]
    v_pk_mul_f32 v[70:71], v[70:71], v[78:79]
    v_pk_mul_f32 v[64:65], v[64:65], v[28:29]
    v_pk_mul_f32 v[66:67], v[66:67], v[28:29]
    v_pk_mul_f32 v[68:69], v[68:69], v[28:29]
    v_pk_mul_f32 v[70:71], v[70:71], v[28:29]
    v_cvt_pk_bf16_f32 v108, v64, v65
    v_cvt_pk_bf16_f32 v109, v66, v67
    v_cvt_pk_bf16_f32 v110, v68, v69
    v_cvt_pk_bf16_f32 v111, v70, v71
    buffer_store_dwordx4 v[108:111], v1, s[56:59], s78 offen offset:0 sc1
    v_pk_mul_f32 v[80:81], v[80:81], v[88:89]
    v_pk_mul_f32 v[82:83], v[82:83], v[90:91]
    v_pk_mul_f32 v[84:85], v[84:85], v[92:93]
    v_pk_mul_f32 v[86:87], v[86:87], v[94:95]
    v_pk_mul_f32 v[80:81], v[80:81], v[30:31]
    v_pk_mul_f32 v[82:83], v[82:83], v[30:31]
    v_pk_mul_f32 v[84:85], v[84:85], v[30:31]
    v_pk_mul_f32 v[86:87], v[86:87], v[30:31]
    v_cvt_pk_bf16_f32 v124, v80, v81
    v_cvt_pk_bf16_f32 v125, v82, v83
    v_cvt_pk_bf16_f32 v126, v84, v85
    v_cvt_pk_bf16_f32 v127, v86, v87
    buffer_store_dwordx4 v[124:127], v1, s[56:59], s79 offen offset:0 sc1
    v_mov_b32 v64, v27
    v_mov_b32 v65, v27
    v_mov_b32 v66, v27
    v_mov_b32 v67, v27
    v_mov_b32 v68, v27
    v_mov_b32 v69, v27
    v_mov_b32 v70, v27
    v_mov_b32 v71, v27
    v_mov_b32 v72, v27
    v_mov_b32 v73, v27
    v_mov_b32 v74, v27
    v_mov_b32 v75, v27
    v_mov_b32 v76, v27
    v_mov_b32 v77, v27
    v_mov_b32 v78, v27
    v_mov_b32 v79, v27
    v_mov_b32 v21, v5
    v_mov_b32 v22, v6
    s_waitcnt lgkmcnt(0)
    s_barrier
    ds_read_b128 v[4:7], v21
    ds_read_b32 v25, v22
    ds_read_b128 v[8:11], v2 offset:0
    ds_read_b128 v[12:15], v2 offset:2048
    s_mov_b64 exec, s[76:77]
    ds_read_b128 v[64:67], v3 offset:0
    ds_read_b128 v[68:71], v3 offset:512
    s_mov_b64 exec, -1
    s_waitcnt lgkmcnt(4)
    v_mov_b32 v24, 0
    v_dot2_f32_bf16 v24, v4, v4, v24
    v_dot2_f32_bf16 v24, v5, v5, v24
    v_dot2_f32_bf16 v24, v6, v6, v24
    v_dot2_f32_bf16 v24, v7, v7, v24
    s_mov_b32 s7, 0x44610000
    s_mov_b32 s83, 2
    s_mov_b32 s82, 0
    s_nop 0
    v_mov_b32 v23, v24
    s_nop 1
    v_permlane32_swap_b32 v24, v23
    s_nop 0
    v_add_f32 v24, v24, v23
    v_mul_f32 v24, v25, v24
    v_cmp_nge_f32 vcc, s7, v24
    s_cmp_eq_u64 vcc, 0
    s_cbranch_scc1 L_FAST
    s_waitcnt vmcnt(0)
    s_barrier
    s_mov_b32 s83, 99
    v_mov_b32 v21, 0xff800000
    v_mov_b32 v22, v1
L_MAXLOOP:
    ds_read_b128 v[80:83], v22
    v_add_u32 v22, 2048, v22
    s_waitcnt lgkmcnt(0)
    v_mfma_f32_32x32x16_bf16 v[32:47], v[80:83], v[4:7], 0
    s_nop 15
    v_max3_f32 v21, v32, v33, v21
    v_max3_f32 v21, v34, v35, v21
    v_max3_f32 v21, v36, v37, v21
    v_max3_f32 v21, v38, v39, v21
    v_max3_f32 v21, v40, v41, v21
    v_max3_f32 v21, v42, v43, v21
    v_max3_f32 v21, v44, v45, v21
    v_max3_f32 v21, v46, v47, v21
    s_add_u32 s82, s82, 1
    s_cmp_lt_u32 s82, 64
    s_cbranch_scc1 L_MAXLOOP
    v_mov_b32 v22, v21
    s_mov_b32 s82, 0
    s_nop 0
    v_permlane32_swap_b32 v21, v22
    s_nop 1
    v_max_f32 v21, v21, v22
    v_sub_f32 v144, 0, v21
    v_sub_f32 v145, 0, v21
    v_sub_f32 v146, 0, v21
    v_sub_f32 v147, 0, v21
    v_sub_f32 v148, 0, v21
    v_sub_f32 v149, 0, v21
    v_sub_f32 v150, 0, v21
    v_sub_f32 v151, 0, v21
    v_sub_f32 v152, 0, v21
    v_sub_f32 v153, 0, v21
    v_sub_f32 v154, 0, v21
    v_sub_f32 v155, 0, v21
    v_sub_f32 v156, 0, v21
    v_sub_f32 v157, 0, v21
    v_sub_f32 v158, 0, v21
    v_sub_f32 v159, 0, v21
L_FAST:
    s_setprio 1
    s_cmp_lt_u32 s3, 4
    s_cbranch_scc0 L_NOPRIO
    s_setprio 2
L_NOPRIO:
    v_mov_b32 v60, 0
    v_mov_b32 v61, 0
    v_mov_b32 v62, 0
    v_mov_b32 v63, 0
    v_mov_b32 v84, 0
    v_mov_b32 v85, 0
    s_waitcnt lgkmcnt(0)
    v_mfma_f32_32x32x16_bf16 v[32:47], v[8:11], v[4:7], v[144:159]
    s_nop 11
L_LOOP:
    s_setprio 2
    v_exp_f32 v32, v32
    v_exp_f32 v33, v33
    v_cvt_pk_bf16_f32 v86, v60, v61
    v_cvt_pk_bf16_f32 v87, v62, v63
    v_exp_f32 v34, v34
    v_exp_f32 v35, v35
    v_mfma_f32_32x32x16_bf16 v[128:143], v[76:79], v[84:87], v[128:143]
    s_mov_b64 exec, s[76:77]
    ds_read_b128 v[72:75], v3 offset:2048
    ds_read_b128 v[76:79], v3 offset:2560
    s_mov_b64 exec, -1
    v_exp_f32 v36, v36
    v_exp_f32 v37, v37
    v_cvt_pk_bf16_f32 v80, v32, v33
    v_cvt_pk_bf16_f32 v81, v34, v35
    s_waitcnt lgkmcnt(2)
    v_mfma_f32_32x32x16_bf16 v[48:63], v[12:15], v[4:7], v[144:159]
    ds_read_b128 v[8:11], v2 offset:4096
    v_exp_f32 v38, v38
    v_exp_f32 v39, v39
    v_exp_f32 v40, v40
    v_exp_f32 v41, v41
    v_cvt_pk_bf16_f32 v82, v36, v37
    v_cvt_pk_bf16_f32 v83, v38, v39
    v_exp_f32 v42, v42
    v_exp_f32 v43, v43
    v_mfma_f32_32x32x16_bf16 v[128:143], v[64:67], v[80:83], v[128:143]
    v_exp_f32 v44, v44
    v_exp_f32 v45, v45
    v_cvt_pk_bf16_f32 v84, v40, v41
    v_cvt_pk_bf16_f32 v85, v42, v43
    v_exp_f32 v46, v46
    v_exp_f32 v47, v47
    v_exp_f32 v48, v48
    v_exp_f32 v49, v49
    v_cvt_pk_bf16_f32 v86, v44, v45
    v_cvt_pk_bf16_f32 v87, v46, v47
    v_exp_f32 v50, v50
    v_exp_f32 v51, v51
    v_mfma_f32_32x32x16_bf16 v[128:143], v[68:71], v[84:87], v[128:143]
    s_mov_b64 exec, s[76:77]
    ds_read_b128 v[64:67], v3 offset:4096
    ds_read_b128 v[68:71], v3 offset:4608
    s_mov_b64 exec, -1
    v_exp_f32 v52, v52
    v_exp_f32 v53, v53
    v_cvt_pk_bf16_f32 v80, v48, v49
    v_cvt_pk_bf16_f32 v81, v50, v51
    s_waitcnt lgkmcnt(2)
    v_mfma_f32_32x32x16_bf16 v[32:47], v[8:11], v[4:7], v[144:159]
    ds_read_b128 v[12:15], v2 offset:6144
    v_exp_f32 v54, v54
    v_exp_f32 v55, v55
    v_exp_f32 v56, v56
    v_exp_f32 v57, v57
    v_cvt_pk_bf16_f32 v82, v52, v53
    v_cvt_pk_bf16_f32 v83, v54, v55
    v_exp_f32 v58, v58
    v_exp_f32 v59, v59
    v_mfma_f32_32x32x16_bf16 v[128:143], v[72:75], v[80:83], v[128:143]
    v_exp_f32 v60, v60
    v_exp_f32 v61, v61
    v_cvt_pk_bf16_f32 v84, v56, v57
    v_cvt_pk_bf16_f32 v85, v58, v59
    v_exp_f32 v62, v62
    v_exp_f32 v63, v63
    s_setprio 1
    v_exp_f32 v32, v32
    v_exp_f32 v33, v33
    v_cvt_pk_bf16_f32 v86, v60, v61
    v_cvt_pk_bf16_f32 v87, v62, v63
    v_exp_f32 v34, v34
    v_exp_f32 v35, v35
    v_mfma_f32_32x32x16_bf16 v[128:143], v[76:79], v[84:87], v[128:143]
    s_mov_b64 exec, s[76:77]
    ds_read_b128 v[72:75], v3 offset:6144
    ds_read_b128 v[76:79], v3 offset:6656
    s_mov_b64 exec, -1
    v_exp_f32 v36, v36
    v_exp_f32 v37, v37
    v_cvt_pk_bf16_f32 v80, v32, v33
    v_cvt_pk_bf16_f32 v81, v34, v35
    s_waitcnt lgkmcnt(2)
    v_mfma_f32_32x32x16_bf16 v[48:63], v[12:15], v[4:7], v[144:159]
    ds_read_b128 v[8:11], v2 offset:8192
    v_exp_f32 v38, v38
    v_exp_f32 v39, v39
    v_exp_f32 v40, v40
    v_exp_f32 v41, v41
    v_cvt_pk_bf16_f32 v82, v36, v37
    v_cvt_pk_bf16_f32 v83, v38, v39
    v_exp_f32 v42, v42
    v_exp_f32 v43, v43
    v_mfma_f32_32x32x16_bf16 v[128:143], v[64:67], v[80:83], v[128:143]
    v_exp_f32 v44, v44
    v_exp_f32 v45, v45
    v_cvt_pk_bf16_f32 v84, v40, v41
    v_cvt_pk_bf16_f32 v85, v42, v43
    v_exp_f32 v46, v46
    v_exp_f32 v47, v47
    v_exp_f32 v48, v48
    v_exp_f32 v49, v49
    v_cvt_pk_bf16_f32 v86, v44, v45
    v_cvt_pk_bf16_f32 v87, v46, v47
    v_exp_f32 v50, v50
    v_exp_f32 v51, v51
    v_mfma_f32_32x32x16_bf16 v[128:143], v[68:71], v[84:87], v[128:143]
    s_mov_b64 exec, s[76:77]
    ds_read_b128 v[64:67], v3 offset:8192
    ds_read_b128 v[68:71], v3 offset:8704
    s_mov_b64 exec, -1
    v_exp_f32 v52, v52
    v_exp_f32 v53, v53
    v_cvt_pk_bf16_f32 v80, v48, v49
    v_cvt_pk_bf16_f32 v81, v50, v51
    s_waitcnt lgkmcnt(2)
    v_mfma_f32_32x32x16_bf16 v[32:47], v[8:11], v[4:7], v[144:159]
    ds_read_b128 v[12:15], v2 offset:10240
    v_exp_f32 v54, v54
    v_exp_f32 v55, v55
    v_exp_f32 v56, v56
    v_exp_f32 v57, v57
    v_cvt_pk_bf16_f32 v82, v52, v53
    v_cvt_pk_bf16_f32 v83, v54, v55
    v_exp_f32 v58, v58
    v_exp_f32 v59, v59
    v_mfma_f32_32x32x16_bf16 v[128:143], v[72:75], v[80:83], v[128:143]
    v_exp_f32 v60, v60
    v_exp_f32 v61, v61
    v_cvt_pk_bf16_f32 v84, v56, v57
    v_cvt_pk_bf16_f32 v85, v58, v59
    v_exp_f32 v62, v62
    v_exp_f32 v63, v63
    s_setprio 2
    v_exp_f32 v32, v32
    v_exp_f32 v33, v33
    v_cvt_pk_bf16_f32 v86, v60, v61
    v_cvt_pk_bf16_f32 v87, v62, v63
    v_exp_f32 v34, v34
    v_exp_f32 v35, v35
    v_mfma_f32_32x32x16_bf16 v[128:143], v[76:79], v[84:87], v[128:143]
    s_mov_b64 exec, s[76:77]
    ds_read_b128 v[72:75], v3 offset:10240
    ds_read_b128 v[76:79], v3 offset:10752
    s_mov_b64 exec, -1
    v_exp_f32 v36, v36
    v_exp_f32 v37, v37
    v_cvt_pk_bf16_f32 v80, v32, v33
    v_cvt_pk_bf16_f32 v81, v34, v35
    s_waitcnt lgkmcnt(2)
    v_mfma_f32_32x32x16_bf16 v[48:63], v[12:15], v[4:7], v[144:159]
    ds_read_b128 v[8:11], v2 offset:12288
    v_exp_f32 v38, v38
    v_exp_f32 v39, v39
    v_exp_f32 v40, v40
    v_exp_f32 v41, v41
    v_cvt_pk_bf16_f32 v82, v36, v37
    v_cvt_pk_bf16_f32 v83, v38, v39
    v_exp_f32 v42, v42
    v_exp_f32 v43, v43
    v_mfma_f32_32x32x16_bf16 v[128:143], v[64:67], v[80:83], v[128:143]
    v_exp_f32 v44, v44
    v_exp_f32 v45, v45
    v_cvt_pk_bf16_f32 v84, v40, v41
    v_cvt_pk_bf16_f32 v85, v42, v43
    v_exp_f32 v46, v46
    v_exp_f32 v47, v47
    v_exp_f32 v48, v48
    v_exp_f32 v49, v49
    v_cvt_pk_bf16_f32 v86, v44, v45
    v_cvt_pk_bf16_f32 v87, v46, v47
    v_exp_f32 v50, v50
    v_exp_f32 v51, v51
    v_mfma_f32_32x32x16_bf16 v[128:143], v[68:71], v[84:87], v[128:143]
    s_mov_b64 exec, s[76:77]
    ds_read_b128 v[64:67], v3 offset:12288
    ds_read_b128 v[68:71], v3 offset:12800
    s_mov_b64 exec, -1
    v_exp_f32 v52, v52
    v_exp_f32 v53, v53
    v_cvt_pk_bf16_f32 v80, v48, v49
    v_cvt_pk_bf16_f32 v81, v50, v51
    s_waitcnt lgkmcnt(2)
    v_mfma_f32_32x32x16_bf16 v[32:47], v[8:11], v[4:7], v[144:159]
    ds_read_b128 v[12:15], v2 offset:14336
    v_exp_f32 v54, v54
    v_exp_f32 v55, v55
    v_exp_f32 v56, v56
    v_exp_f32 v57, v57
    v_cvt_pk_bf16_f32 v82, v52, v53
    v_cvt_pk_bf16_f32 v83, v54, v55
    v_exp_f32 v58, v58
    v_exp_f32 v59, v59
    v_mfma_f32_32x32x16_bf16 v[128:143], v[72:75], v[80:83], v[128:143]
    v_exp_f32 v60, v60
    v_exp_f32 v61, v61
    v_cvt_pk_bf16_f32 v84, v56, v57
    v_cvt_pk_bf16_f32 v85, v58, v59
    v_exp_f32 v62, v62
    v_exp_f32 v63, v63
    s_setprio 1
    v_exp_f32 v32, v32
    v_exp_f32 v33, v33
    v_cvt_pk_bf16_f32 v86, v60, v61
    v_cvt_pk_bf16_f32 v87, v62, v63
    v_exp_f32 v34, v34
    v_exp_f32 v35, v35
    v_mfma_f32_32x32x16_bf16 v[128:143], v[76:79], v[84:87], v[128:143]
    s_mov_b64 exec, s[76:77]
    ds_read_b128 v[72:75], v3 offset:14336
    ds_read_b128 v[76:79], v3 offset:14848
    s_mov_b64 exec, -1
    v_exp_f32 v36, v36
    v_exp_f32 v37, v37
    v_cvt_pk_bf16_f32 v80, v32, v33
    v_cvt_pk_bf16_f32 v81, v34, v35
    s_waitcnt lgkmcnt(2)
    v_mfma_f32_32x32x16_bf16 v[48:63], v[12:15], v[4:7], v[144:159]
    ds_read_b128 v[8:11], v2 offset:16384
    v_exp_f32 v38, v38
    v_exp_f32 v39, v39
    v_exp_f32 v40, v40
    v_exp_f32 v41, v41
    v_cvt_pk_bf16_f32 v82, v36, v37
    v_cvt_pk_bf16_f32 v83, v38, v39
    v_exp_f32 v42, v42
    v_exp_f32 v43, v43
    v_mfma_f32_32x32x16_bf16 v[128:143], v[64:67], v[80:83], v[128:143]
    v_exp_f32 v44, v44
    v_exp_f32 v45, v45
    v_cvt_pk_bf16_f32 v84, v40, v41
    v_cvt_pk_bf16_f32 v85, v42, v43
    v_exp_f32 v46, v46
    v_exp_f32 v47, v47
    v_exp_f32 v48, v48
    v_exp_f32 v49, v49
    v_cvt_pk_bf16_f32 v86, v44, v45
    v_cvt_pk_bf16_f32 v87, v46, v47
    v_exp_f32 v50, v50
    v_exp_f32 v51, v51
    v_mfma_f32_32x32x16_bf16 v[128:143], v[68:71], v[84:87], v[128:143]
    s_mov_b64 exec, s[76:77]
    ds_read_b128 v[64:67], v3 offset:16384
    ds_read_b128 v[68:71], v3 offset:16896
    s_mov_b64 exec, -1
    v_exp_f32 v52, v52
    v_exp_f32 v53, v53
    v_cvt_pk_bf16_f32 v80, v48, v49
    v_cvt_pk_bf16_f32 v81, v50, v51
    s_waitcnt lgkmcnt(2)
    v_mfma_f32_32x32x16_bf16 v[32:47], v[8:11], v[4:7], v[144:159]
    ds_read_b128 v[12:15], v2 offset:18432
    v_exp_f32 v54, v54
    v_exp_f32 v55, v55
    v_exp_f32 v56, v56
    v_exp_f32 v57, v57
    v_cvt_pk_bf16_f32 v82, v52, v53
    v_cvt_pk_bf16_f32 v83, v54, v55
    v_exp_f32 v58, v58
    v_exp_f32 v59, v59
    v_mfma_f32_32x32x16_bf16 v[128:143], v[72:75], v[80:83], v[128:143]
    v_exp_f32 v60, v60
    v_exp_f32 v61, v61
    v_cvt_pk_bf16_f32 v84, v56, v57
    v_cvt_pk_bf16_f32 v85, v58, v59
    v_exp_f32 v62, v62
    v_exp_f32 v63, v63
    v_add_u32 v2, 16384, v2
    v_add_u32 v3, 16384, v3
    s_add_u32 s82, s82, 1
    s_cmp_lg_u32 s82, s83
    s_cbranch_scc1 L_NOBKV
    s_waitcnt vmcnt(0)
    s_barrier
L_NOBKV:
    s_cmp_lt_u32 s82, 8
    s_cbranch_scc1 L_LOOP
    v_cvt_pk_bf16_f32 v86, v60, v61
    v_cvt_pk_bf16_f32 v87, v62, v63
    s_nop 1
    v_mfma_f32_32x32x16_bf16 v[128:143], v[76:79], v[84:87], v[128:143]
    s_nop 12
    v_rcp_f32 v21, v136
    v_lshrrev_b32 v25, 3, v0
    v_mul_f32 v21, v21, v26
    v_mul_f32 v128, v128, v21
    v_mul_f32 v129, v129, v21
    v_mul_f32 v130, v130, v21
    v_mul_f32 v131, v131, v21
    v_mul_f32 v132, v132, v21
    v_mul_f32 v133, v133, v21
    v_mul_f32 v134, v134, v21
    v_mul_f32 v135, v135, v21
    v_cvt_pk_bf16_f32 v136, v128, v129
    v_cvt_pk_bf16_f32 v137, v130, v131
    v_cvt_pk_bf16_f32 v138, v132, v133
    v_cvt_pk_bf16_f32 v139, v134, v135
    buffer_store_dwordx4 v[136:139], v1, s[56:59], s86 offen sc1
    s_waitcnt lgkmcnt(0)
    s_barrier
    s_lshl_b32 s6, s3, 3
    v_add_u32 v25, s6, v25
    v_and_b32 v22, 15, v25
    v_and_b32 v23, 7, v0
    v_lshlrev_b32 v24, 1, v23
    v_xor_b32 v22, v22, v24
    v_lshlrev_b32 v24, 8, v25
    v_lshl_add_u32 v8, v22, 4, v24
    v_xor_b32 v9, 16, v8
    v_lshlrev_b32 v25, 10, v25
    v_lshl_add_u32 v10, v23, 4, v25
    s_lshl_b32 s6, s14, 16
    s_lshl_b32 s7, s15, 7
    s_add_u32 s6, s6, s7
    s_barrier
    ds_read_b128 v[32:35], v8 offset:0
    ds_read_b128 v[36:39], v9 offset:0
    ds_read_b128 v[40:43], v8 offset:16384
    ds_read_b128 v[44:47], v9 offset:16384
    ds_read_b128 v[48:51], v8 offset:32768
    ds_read_b128 v[52:55], v9 offset:32768
    ds_read_b128 v[56:59], v8 offset:49152
    ds_read_b128 v[60:63], v9 offset:49152
    s_waitcnt lgkmcnt(4)
    v_add_f32 v32, v32, v40
    v_add_f32 v33, v33, v41
    v_add_f32 v34, v34, v42
    v_add_f32 v35, v35, v43
    v_add_f32 v36, v36, v44
    v_add_f32 v37, v37, v45
    v_add_f32 v38, v38, v46
    v_add_f32 v39, v39, v47
    s_waitcnt lgkmcnt(2)
    v_add_f32 v32, v32, v48
    v_add_f32 v33, v33, v49
    v_add_f32 v34, v34, v50
    v_add_f32 v35, v35, v51
    v_add_f32 v36, v36, v52
    v_add_f32 v37, v37, v53
    v_add_f32 v38, v38, v54
    v_add_f32 v39, v39, v55
    s_waitcnt lgkmcnt(0)
    v_add_f32 v32, v32, v56
    v_add_f32 v33, v33, v57
    v_add_f32 v34, v34, v58
    v_add_f32 v35, v35, v59
    v_add_f32 v36, v36, v60
    v_add_f32 v37, v37, v61
    v_add_f32 v38, v38, v62
    v_add_f32 v39, v39, v63
    v_cvt_pk_bf16_f32 v40, v32, v33
    v_cvt_pk_bf16_f32 v41, v34, v35
    v_cvt_pk_bf16_f32 v42, v36, v37
    v_cvt_pk_bf16_f32 v43, v38, v39
    buffer_store_dwordx4 v[40:43], v10, s[44:47], s6 offen
    s_endpgm
L_CODE_END:
.section .rodata,"a"
.p2align 6
.amdhsa_kernel gated_mix__grouped_kv_mqa__glu_gated_bilinear__prompt_kernel
  .amdhsa_next_free_vgpr 168
  .amdhsa_next_free_sgpr 102
  .amdhsa_accum_offset 168
  .amdhsa_group_segment_fixed_size 0
  .amdhsa_kernarg_size 104
  .amdhsa_user_sgpr_count 2
  .amdhsa_user_sgpr_kernarg_segment_ptr 1
  .amdhsa_system_sgpr_workgroup_id_x 1
.end_amdhsa_kernel
```
